```python
import torch

def _softmax(x, axis=-1):
    return torch.softmax(x, dim=axis)
def _gelu(x):
    return torch.nn.functional.gelu(x, approximate="tanh")
def _silu(x):
    return torch.nn.functional.silu(x)
def _sigmoid(x):
    return torch.sigmoid(x)
def _layernorm(x, axis=-1, eps=1e-5):
    m = x.mean(dim=axis, keepdim=True)
    v = x.var(dim=axis, keepdim=True, unbiased=False)
    return (x - m) / torch.sqrt(v + eps)
def _scatter_add(tgt, idx, src, axis=0):
    return tgt.clone().index_add_(axis, idx, src)
def _segment_sum(src, seg, n):
    out = torch.zeros((n,) + src.shape[1:], dtype=src.dtype)
    return out.index_add_(0, seg, src)
def _pad(x, pw):
    flat = tuple(v for pair in reversed(pw) for v in pair)
    return torch.nn.functional.pad(x, flat)

kernel_name = 'parallel_sum__gqa_block_cached__glu_gated_swiglu__decode'

def setup_inputs():

    _w = (lambda a: (lambda t: t.to(torch.bfloat16) if t.is_floating_point() else t)(torch.as_tensor(a)))
    def _A_setup():
        B, Sq, D = 1, 1, 640
        Hq, Hkv, Sk, Dh = 32, 32, 8192, 128
        assert Hq % Hkv == 0, (Hq, Hkv)
        return {
            "x": _w((lambda *s: torch.randn(*s, dtype=torch.bfloat16) * 0.05)(B, Sq, D)),
            "k_cache": _w((lambda *s: torch.randn(*s, dtype=torch.bfloat16) * 1.6)(B, Hkv, Sk, Dh)),
            "v_cache": _w((lambda *s: torch.randn(*s, dtype=torch.bfloat16) * 0.8)(B, Hkv, Sk, Dh)),
            "wq": _w((lambda *s: torch.randn(*s, dtype=torch.bfloat16) * 1.6)(D, Hq * Dh) * (D ** -0.5)),
            "wo": _w((lambda *s: torch.randn(*s, dtype=torch.bfloat16) * 0.8)(Hq * Dh, D) * ((Hq * Dh) ** -0.5)),
        }
    _A_in = _A_setup()

    def _B_setup():
        B, S, D, F = 1, 1, 640, 1728
        return {
            "x": _w((lambda *s: torch.randn(*s, dtype=torch.bfloat16) * 0.05)(B, S, D)),
            "w1": _w((lambda *s: torch.randn(*s, dtype=torch.bfloat16) * 0.4)(D, F) * (2.0 / D) ** 0.5),
            "w3": _w((lambda *s: torch.randn(*s, dtype=torch.bfloat16) * 0.4)(D, F) * (2.0 / D) ** 0.5),
            "w2": _w((lambda *s: torch.randn(*s, dtype=torch.bfloat16) * 0.4)(F, D) * (2.0 / F) ** 0.5),
        }
    _B_in = _B_setup()

    return {
        "A_x": _A_in["x"],
        "A_k_cache": _A_in["k_cache"],
        "A_v_cache": _A_in["v_cache"],
        "A_wq": _A_in["wq"],
        "A_wo": _A_in["wo"],
        "B_x": _B_in["x"],
        "B_w1": _B_in["w1"],
        "B_w3": _B_in["w3"],
        "B_w2": _B_in["w2"],
    }

def reference(A_x, A_k_cache, A_v_cache, A_wq, A_wo, B_x, B_w1, B_w3, B_w2):
    def _A_ref(x, k_cache, v_cache, wq, wo):
        B, Sq, D = x.shape
        Hq, Dh = 32, 128
        Hkv = k_cache.shape[1]
        rep = Hq // Hkv
        q = (lambda x, *d: x.permute(*d))((x @ wq).reshape(B, Sq, Hq, Dh), 0, 2, 1, 3)
        k = (lambda x, n, axis: torch.repeat_interleave(x, n, dim=axis))(k_cache, rep, axis=1)
        v = (lambda x, n, axis: torch.repeat_interleave(x, n, dim=axis))(v_cache, rep, axis=1)
        scores = torch.einsum("bhqd,bhkd->bhqk", q, k) * (Dh ** -0.5)
        p = _softmax(scores, axis=-1)
        o = torch.einsum("bhqk,bhkd->bhqd", p, v)
        return (lambda x, *d: x.permute(*d))(o, 0, 2, 1, 3).reshape(B, Sq, Hq * Dh) @ wo

    def _B_ref(x, w1, w3, w2):
        gate = torch.einsum("bsd,df->bsf", x, w1)
        up = torch.einsum("bsd,df->bsf", x, w3)
        h = _silu(gate) * up
        out = torch.einsum("bsf,fd->bsd", h, w2)
        return out

    x = A_x
    xn = _layernorm(x, axis=-1)
    return x + _A_ref(xn, A_k_cache, A_v_cache, A_wq, A_wo) + _B_ref(xn, B_w1, B_w3, B_w2)
```

```asm
; @launch grid=(256,1,1) block=(512,1,1) lds=163840
.amdgcn_target "amdgcn-amd-amdhsa--gfx950"
.text
.globl parallel_sum__gqa_block_cached__glu_gated_swiglu__decode_kernel
.p2align 8
.type parallel_sum__gqa_block_cached__glu_gated_swiglu__decode_kernel,@function
parallel_sum__gqa_block_cached__glu_gated_swiglu__decode_kernel:

    s_cmp_ge_u32 s2, 256
    s_cbranch_scc1 L_end

    s_load_dwordx16 s[4:19], s[0:1], 0
    s_load_dwordx8 s[20:27], s[0:1], 64
    v_and_b32 v1, 63, v0
    v_lshrrev_b32 v10, 6, v0
    v_lshlrev_b32 v2, 4, v1
    v_readfirstlane_b32 s3, v10
    v_and_b32 v3, 15, v1
    v_lshrrev_b32 v4, 4, v1
    s_and_b32 s30, s2, 7
    s_lshr_b32 s31, s2, 3
    s_and_b32 s29, s31, 7
    s_lshr_b32 s31, s31, 3

    s_xor_b32 s30, s30, 0
    s_lshl_b32 s28, s30, 1
    s_and_b32 s63, s31, 1
    s_add_u32 s28, s28, s63
    s_lshr_b32 s63, s31, 1
    s_lshl_b32 s63, s63, 4
    s_add_u32 s28, s28, s63

    s_mov_b32 s64, 0xcccccccc
    s_mov_b32 s65, 0xcccccccc
    s_mov_b32 s66, 0xaaaaaaaa
    s_mov_b32 s67, 0xaaaaaaaa
    s_mov_b32 s87, 20000
    s_mov_b32 s61, 0x0c0c0400
    s_mov_b32 s62, 0x04000c0c
    v_mov_b32 v6, 0xffffff00

    s_and_b32 s30, s2, 7
    s_lshr_b32 s70, s30, 1
    s_lshr_b32 s31, s2, 6
    s_lshl_b32 s31, s31, 2
    s_add_u32 s70, s70, s31
    s_and_b32 s30, s30, 1

    s_cmp_lt_u32 s70, 14
    s_cselect_b32 s71, 1, 0
    s_cmp_lt_u32 s70, 5
    s_cselect_b32 s77, 1, 0
    s_mov_b32 s79, s71
    s_cmp_eq_u32 s30, 0
    s_cselect_b32 s71, s71, 0
    s_cselect_b32 s77, 0, s77
    s_cmp_lt_u32 s29, 4
    s_cselect_b32 s77, s77, 0

    s_lshl_b32 s30, s28, 3
    s_add_u32 s30, s30, s29
    s_lshl_b32 s30, s30, 18
    s_waitcnt lgkmcnt(0)

    s_add_u32 s32, s6, s30
    s_addc_u32 s33, s7, 0
    s_mov_b32 s34, 0x40000
    s_mov_b32 s35, 0x20000

    s_cmp_lg_u32 s3, 7
    s_cbranch_scc1 L_noburst
    s_mov_b32 s75, 0
    s_mov_b32 s74, 16384

    s_mov_b32 m0, s74
    s_add_u32 s74, s74, 4096
    buffer_load_dwordx4 v2, s[32:35], s75 offen offset:0 nt lds
    buffer_load_dwordx4 v2, s[32:35], s75 offen offset:1024 nt lds
    buffer_load_dwordx4 v2, s[32:35], s75 offen offset:2048 nt lds
    buffer_load_dwordx4 v2, s[32:35], s75 offen offset:3072 nt lds
    s_mov_b32 m0, s74
    s_add_u32 s75, s75, 4096
    buffer_load_dwordx4 v2, s[32:35], s75 offen offset:0 nt lds
    buffer_load_dwordx4 v2, s[32:35], s75 offen offset:1024 nt lds
    buffer_load_dwordx4 v2, s[32:35], s75 offen offset:2048 nt lds
    buffer_load_dwordx4 v2, s[32:35], s75 offen offset:3072 nt lds
    s_add_u32 s74, s74, 4096
    s_add_u32 s75, s75, 4096
    s_mov_b32 m0, s74
    s_add_u32 s74, s74, 4096
    buffer_load_dwordx4 v2, s[32:35], s75 offen offset:0 nt lds
    buffer_load_dwordx4 v2, s[32:35], s75 offen offset:1024 nt lds
    buffer_load_dwordx4 v2, s[32:35], s75 offen offset:2048 nt lds
    buffer_load_dwordx4 v2, s[32:35], s75 offen offset:3072 nt lds
    s_mov_b32 m0, s74
    s_add_u32 s75, s75, 4096
    buffer_load_dwordx4 v2, s[32:35], s75 offen offset:0 nt lds
    buffer_load_dwordx4 v2, s[32:35], s75 offen offset:1024 nt lds
    buffer_load_dwordx4 v2, s[32:35], s75 offen offset:2048 nt lds
    buffer_load_dwordx4 v2, s[32:35], s75 offen offset:3072 nt lds
    s_add_u32 s74, s74, 4096
    s_add_u32 s75, s75, 4096
    s_mov_b32 m0, s74
    s_add_u32 s74, s74, 4096
    buffer_load_dwordx4 v2, s[32:35], s75 offen offset:0 nt lds
    buffer_load_dwordx4 v2, s[32:35], s75 offen offset:1024 nt lds
    buffer_load_dwordx4 v2, s[32:35], s75 offen offset:2048 nt lds
    buffer_load_dwordx4 v2, s[32:35], s75 offen offset:3072 nt lds
    s_mov_b32 m0, s74
    s_add_u32 s75, s75, 4096
    buffer_load_dwordx4 v2, s[32:35], s75 offen offset:0 nt lds
    buffer_load_dwordx4 v2, s[32:35], s75 offen offset:1024 nt lds
    buffer_load_dwordx4 v2, s[32:35], s75 offen offset:2048 nt lds
    buffer_load_dwordx4 v2, s[32:35], s75 offen offset:3072 nt lds
    s_add_u32 s74, s74, 4096
    s_add_u32 s75, s75, 4096
    s_mov_b32 m0, s74
    s_add_u32 s74, s74, 4096
    buffer_load_dwordx4 v2, s[32:35], s75 offen offset:0 nt lds
    buffer_load_dwordx4 v2, s[32:35], s75 offen offset:1024 nt lds
    buffer_load_dwordx4 v2, s[32:35], s75 offen offset:2048 nt lds
    buffer_load_dwordx4 v2, s[32:35], s75 offen offset:3072 nt lds
    s_mov_b32 m0, s74
    s_add_u32 s75, s75, 4096
    buffer_load_dwordx4 v2, s[32:35], s75 offen offset:0 nt lds
    buffer_load_dwordx4 v2, s[32:35], s75 offen offset:1024 nt lds
    buffer_load_dwordx4 v2, s[32:35], s75 offen offset:2048 nt lds
    buffer_load_dwordx4 v2, s[32:35], s75 offen offset:3072 nt lds
    s_add_u32 s74, s74, 4096
    s_add_u32 s75, s75, 4096
    s_mov_b32 m0, s74
    s_add_u32 s74, s74, 4096
    buffer_load_dwordx4 v2, s[32:35], s75 offen offset:0 nt lds
    buffer_load_dwordx4 v2, s[32:35], s75 offen offset:1024 nt lds
    buffer_load_dwordx4 v2, s[32:35], s75 offen offset:2048 nt lds
    buffer_load_dwordx4 v2, s[32:35], s75 offen offset:3072 nt lds
    s_mov_b32 m0, s74
    s_add_u32 s75, s75, 4096
    buffer_load_dwordx4 v2, s[32:35], s75 offen offset:0 nt lds
    buffer_load_dwordx4 v2, s[32:35], s75 offen offset:1024 nt lds
    buffer_load_dwordx4 v2, s[32:35], s75 offen offset:2048 nt lds
    buffer_load_dwordx4 v2, s[32:35], s75 offen offset:3072 nt lds
    s_add_u32 s74, s74, 4096
    s_add_u32 s75, s75, 4096
L_noburst:

    s_nop 0
    s_mul_i32 s30, s3, 20
    s_and_b32 s31, s3, 1
    s_mul_i32 s31, s31, 40
    s_cmp_lt_u32 s3, 4
    s_cselect_b32 s30, s30, s31
    s_movk_i32 s88, 13824
    s_cselect_b32 s88, 32768, s88
    s_movk_i32 s69, 3456
    s_cselect_b32 s69, 8192, s69
    s_cselect_b32 s68, 0, s70
    s_mul_i32 s31, s29, 80
    s_add_u32 s30, s30, s31
    v_mul_lo_u32 v7, v4, s69
    v_lshl_add_u32 v7, v3, 4, v7
    v_add_u32 v62, s30, v4
    v_lshlrev_b32 v62, 1, v62
    s_mul_i32 s30, s30, s69
    s_cmp_eq_u32 s68, 13
    s_cselect_b32 s68, 8, 16
    s_movk_i32 s63, 256
    s_cselect_b32 s63, 128, s63
    v_mov_b32 v11, 0x40000000
    v_cmp_gt_u32 vcc, s68, v3
    s_nop 1
    v_cndmask_b32 v7, v11, v7, vcc
    s_cmp_eq_u32 s3, 6
    s_mov_b32 s68, 134784
    s_cselect_b32 s68, 273024, s68
    s_add_u32 s63, s63, s68
    s_mul_i32 s68, s71, s63
    s_lshl_b32 s31, s70, 7
    s_add_u32 s31, s31, 1536
    s_lshl_b32 s63, s70, 8
    s_cmp_ge_u32 s70, 99
    s_cselect_b32 s63, s31, s63
    s_lshl_b32 s31, s28, 8
    s_cmp_lt_u32 s3, 4
    s_cselect_b32 s31, s31, s63
    s_add_u32 s30, s30, s31
    s_cmp_lt_u32 s3, 4
    s_cselect_b32 s63, 155904, s68
    s_cmp_lt_u32 s3, 6
    s_cselect_b32 s40, s16, s18
    s_cselect_b32 s41, s17, s19

    s_cmp_lt_u32 s3, 4
    s_cselect_b32 s40, s10, s40
    s_cselect_b32 s41, s11, s41
    s_add_u32 s40, s40, s30
    s_addc_u32 s41, s41, 0
    s_mov_b32 s42, s63

    s_mov_b32 s43, 0x20000
    s_mov_b32 s52, s4
    s_mov_b32 s53, s5
    s_movk_i32 s54, 1280
    s_mov_b32 s55, 0x20000

    s_cmp_eq_u32 s3, 7
    s_cbranch_scc1 L_post1

    v_lshlrev_b32 v11, 2, v1
    buffer_load_dwordx4 v[16:19], v2, s[52:55], 0 offen
    buffer_load_dword v20, v11, s[52:55], 0 offen offset:1024
    s_mov_b32 s75, 0
    buffer_load_dwordx4 v[128:131], v7, s[40:43], s75 offen nt
    s_add_u32 s75, s75, s88
    buffer_load_dwordx4 v[132:135], v7, s[40:43], s75 offen nt
    s_add_u32 s75, s75, s88
    buffer_load_dwordx4 v[136:139], v7, s[40:43], s75 offen nt
    s_add_u32 s75, s75, s88
    buffer_load_dwordx4 v[140:143], v7, s[40:43], s75 offen nt
    s_add_u32 s75, s75, s88
    buffer_load_dwordx4 v[144:147], v7, s[40:43], s75 offen nt
    s_add_u32 s75, s75, s88

    s_cmp_lt_u32 s3, 4
    s_cbranch_scc1 L_post1

    buffer_load_dwordx4 v[64:67], v7, s[40:43], s75 offen nt
    s_add_u32 s75, s75, s88
    buffer_load_dwordx4 v[68:71], v7, s[40:43], s75 offen nt
    s_add_u32 s75, s75, s88
    buffer_load_dwordx4 v[72:75], v7, s[40:43], s75 offen nt
    s_add_u32 s75, s75, s88
    buffer_load_dwordx4 v[76:79], v7, s[40:43], s75 offen nt
    s_add_u32 s75, s75, s88
    buffer_load_dwordx4 v[80:83], v7, s[40:43], s75 offen nt
    s_add_u32 s75, s75, s88
L_post1:
    s_lshl_b32 s30, s28, 3
    s_add_u32 s30, s30, s29
    s_lshl_b32 s30, s30, 18
    s_add_u32 s36, s8, s30
    s_addc_u32 s37, s9, 0
    s_mov_b32 s38, 0x40000
    s_mov_b32 s39, 0x20000

    s_lshl_b32 s30, s28, 3
    s_add_u32 s30, s30, s29
    s_mul_i32 s30, s30, 20480
    s_sub_u32 s97, s3, 1
    s_lshl_b32 s31, s97, 8
    s_cmp_lt_u32 s97, 5
    s_cselect_b32 s31, s31, 0
    s_cselect_b32 s63, 1, 0
    s_add_u32 s30, s30, s31
    s_mul_i32 s68, s63, 19456

    s_add_u32 s44, s12, s30
    s_addc_u32 s45, s13, 0
    s_mov_b32 s46, s68
    s_mov_b32 s47, 0x20000

    s_lshl_b32 s30, s70, 3
    s_add_u32 s30, s30, s29
    s_cmp_lt_u32 s30, 108
    s_cselect_b32 s63, s63, 0
    s_and_b32 s68, s2, 1
    s_xor_b32 s68, s68, 0
    s_cmp_lt_u32 s97, 5
    s_cselect_b32 s69, 0, 1
    s_cmp_eq_u32 s68, s69
    s_cselect_b32 s79, s79, 0
    s_mul_i32 s30, s30, 20480
    s_add_u32 s30, s30, s31
    s_mul_i32 s63, s63, s79
    s_mul_i32 s30, s30, s63
    s_mul_i32 s68, s63, 19456

    s_add_u32 s48, s20, s30
    s_addc_u32 s49, s21, 0
    s_mov_b32 s50, s68
    s_mov_b32 s51, 0x20000

    v_lshlrev_b32 v11, 4, v3
    v_mul_u32_u24 v8, 5120, v4
    v_add_u32 v8, v8, v11
    s_lshl_b32 s30, s28, 13
    s_add_u32 s30, s30, 4096

    s_add_u32 s80, s26, s30
    s_addc_u32 s81, s27, 0

    s_lshl_b32 s30, s28, 13
    s_add_u32 s30, s30, 2359296

    s_add_u32 s88, s26, s30
    s_addc_u32 s89, s27, 0

    s_lshl_b32 s30, s28, 12
    s_add_u32 s30, s30, 3145728

    s_add_u32 s82, s26, s30
    s_addc_u32 s83, s27, 0

    s_add_u32 s92, s82, 262144
    s_addc_u32 s93, s83, 0

    s_add_u32 s24, s80, 2093056
    s_addc_u32 s25, s81, 0
    s_lshl_b32 s30, s70, 13
    s_add_u32 s30, s30, 2621440
    s_add_u32 s94, s26, s30
    s_addc_u32 s95, s27, 0

    s_lshl_b32 s30, s28, 3
    s_add_u32 s30, s30, s29
    s_lshl_b32 s30, s30, 7
    s_and_b32 s31, s97, 7
    s_lshl_b32 s31, s31, 17
    s_add_u32 s30, s30, s31
    s_add_u32 s30, s30, 524288

    s_add_u32 s84, s26, s30
    s_addc_u32 s85, s27, 0

    s_lshl_b32 s96, s70, 2
    s_add_u32 s96, s96, s29
    s_mul_i32 s96, s96, s77
    s_lshl_b32 s30, s96, 15
    s_lshl_b32 s31, s3, 12
    s_add_u32 s30, s30, s31
    s_add_u32 s30, s30, 524288

    s_add_u32 s98, s26, s30
    s_addc_u32 s99, s27, 0

    v_lshrrev_b32 v11, 2, v3
    v_lshlrev_b32 v60, 15, v11
    v_and_b32 v11, 3, v3
    v_lshl_add_u32 v60, v11, 5, v60
    v_lshrrev_b32 v11, 1, v4
    v_lshl_add_u32 v60, v11, 4, v60

    v_lshrrev_b32 v11, 5, v1
    v_and_b32 v180, 31, v1
    v_lshlrev_b32 v180, 4, v180
    v_lshl_add_u32 v180, v11, 10, v180
    v_min_u32 v63, 39, v1
    v_lshlrev_b32 v63, 4, v63
    v_and_b32 v12, 7, v3
    s_lshl_b32 s30, s29, 7
    v_mov_b32 v104, s30
    s_lshl_b32 s30, s29, 10
    v_add_u32 v112, s30, v2
    s_lshl_b32 s30, s29, 9
    v_add_u32 v120, s30, v2
    s_lshl_b32 s30, s29, 6
    v_lshl_add_u32 v97, v4, 4, s30
    v_lshl_add_u32 v97, v12, 9, v97
    v_lshrrev_b32 v11, 5, v1
    v_and_b32 v5, 31, v1
    v_lshlrev_b32 v5, 4, v5
    v_lshl_add_u32 v5, v11, 10, v5
    v_add_u32 v247, 4096, v5
    s_lshl_b32 s30, s29, 6
    v_lshrrev_b32 v11, 3, v3
    v_lshl_add_u32 v255, v11, 9, s30
    v_lshrrev_b32 v11, 0, v4
    v_lshl_add_u32 v255, v11, 4, v255
    v_lshl_add_u32 v255, v12, 10, v255
    v_mov_b32 v11, 0
    v_lshlrev_b32 v12, 2, v1
    s_mov_b32 exec_hi, 0
    s_mov_b32 exec_lo, 0xffff
    ds_write_b32 v12, v11 offset:8448
    s_mov_b64 exec, -1
    ds_write_b32 v12, v11 offset:8704
    ds_write_b32 v12, v11 offset:9216

    s_waitcnt lgkmcnt(0)
    s_barrier
    s_cmp_eq_u32 s3, 7
    s_cbranch_scc1 L_loader
    s_load_dword s56, s[26:27], 0
    v_mov_b32 v38, v62

    v_add_u32 v39, 8, v38
    v_add_u32 v40, 8, v39
    v_add_u32 v41, 8, v40
    v_add_u32 v42, 8, v41
    s_waitcnt vmcnt(5)

    v_lshlrev_b32 v14, 2, v1
    ds_write_b128 v2, v[16:19] offset:10240
    ds_write_b32 v14, v20 offset:11264

    ds_read_u16 v24, v38 offset:10240
    ds_read_u16 v25, v39 offset:10240
    ds_read_u16 v26, v40 offset:10240
    ds_read_u16 v27, v41 offset:10240
    ds_read_u16 v28, v42 offset:10240

    s_lshl_b32 s30, s96, 6
    v_and_b32 v15, 31, v1
    v_lshl_add_u32 v15, v15, 1, s30
    ds_read_u16 v61, v15 offset:10240

    v_mov_b32 v12, 0x3f803f80
    v_dot2_f32_bf16 v29, v16, v12, 0
    v_dot2_f32_bf16 v30, v16, v16, 0
    v_dot2_f32_bf16 v29, v17, v12, v29
    v_dot2_f32_bf16 v30, v17, v17, v30
    v_dot2_f32_bf16 v29, v18, v12, v29
    v_dot2_f32_bf16 v30, v18, v18, v30
    v_dot2_f32_bf16 v29, v19, v12, v29
    v_dot2_f32_bf16 v30, v19, v19, v30
    v_dot2_f32_bf16 v29, v20, v12, v29
    v_dot2_f32_bf16 v30, v20, v20, v30
    s_nop 1
    v_add_f32_dpp v29, v29, v29 quad_perm:[1,0,3,2] row_mask:0xf bank_mask:0xf
    v_add_f32_dpp v30, v30, v30 quad_perm:[1,0,3,2] row_mask:0xf bank_mask:0xf
    s_nop 0
    v_add_f32_dpp v29, v29, v29 quad_perm:[2,3,0,1] row_mask:0xf bank_mask:0xf
    v_add_f32_dpp v30, v30, v30 quad_perm:[2,3,0,1] row_mask:0xf bank_mask:0xf
    s_nop 0
    v_add_f32_dpp v29, v29, v29 row_half_mirror row_mask:0xf bank_mask:0xf
    v_add_f32_dpp v30, v30, v30 row_half_mirror row_mask:0xf bank_mask:0xf
    s_nop 0
    v_add_f32_dpp v29, v29, v29 row_mirror row_mask:0xf bank_mask:0xf
    v_add_f32_dpp v30, v30, v30 row_mirror row_mask:0xf bank_mask:0xf
    v_mov_b32 v12, v29
    v_mov_b32 v13, v30
    s_nop 0
    v_permlane16_swap_b32 v12, v29
    v_permlane16_swap_b32 v13, v30
    v_add_f32 v29, v29, v12
    v_add_f32 v30, v30, v13
    v_mov_b32 v12, v29
    v_mov_b32 v13, v30
    s_nop 0
    v_permlane32_swap_b32 v12, v29
    v_permlane32_swap_b32 v13, v30
    v_add_f32 v29, v29, v12
    v_add_f32 v30, v30, v13

    v_mul_f32 v29, 986500301, v29
    v_mul_f32 v30, 986500301, v30
    v_fma_f32 v30, -v29, v29, v30

    v_cvt_pk_bf16_f32 v29, 0, v29
    v_cvt_pk_bf16_f32 v30, 0, v30
    v_add_f32 v30, 925353388, v30
    v_cvt_pk_bf16_f32 v30, 0, v30
    v_sqrt_f32 v30, v30
    s_nop 0
    v_cvt_pk_bf16_f32 v30, 0, v30
    v_rcp_f32 v30, v30
    s_waitcnt lgkmcnt(0)
    v_lshlrev_b32 v24, 16, v24
    v_lshlrev_b32 v25, 16, v25
    v_lshlrev_b32 v26, 16, v26
    v_lshlrev_b32 v27, 16, v27
    v_lshlrev_b32 v28, 16, v28
    v_sub_f32 v24, v24, v29
    v_sub_f32 v25, v25, v29
    v_sub_f32 v26, v26, v29
    v_sub_f32 v27, v27, v29
    v_sub_f32 v28, v28, v29
    v_cvt_pk_bf16_f32 v24, 0, v24
    v_cvt_pk_bf16_f32 v25, 0, v25
    v_cvt_pk_bf16_f32 v26, 0, v26
    v_cvt_pk_bf16_f32 v27, 0, v27
    v_cvt_pk_bf16_f32 v28, 0, v28
    v_mul_f32 v24, v24, v30
    v_mul_f32 v25, v25, v30
    v_mul_f32 v26, v26, v30
    v_mul_f32 v27, v27, v30
    v_mul_f32 v28, v28, v30
    v_cvt_pk_bf16_f32 v43, 0, v24
    v_cvt_pk_bf16_f32 v44, 0, v25
    v_cvt_pk_bf16_f32 v45, 0, v26
    v_cvt_pk_bf16_f32 v46, 0, v27
    v_cvt_pk_bf16_f32 v47, 0, v28
    v_lshrrev_b32 v38, 16, v43
    v_lshrrev_b32 v39, 16, v44
    v_lshrrev_b32 v40, 16, v45
    v_lshrrev_b32 v41, 16, v46
    v_lshrrev_b32 v42, 16, v47
    v_mov_b32 v48, 0
    v_mov_b32 v49, 0
    v_mov_b32 v50, 0
    v_mov_b32 v51, 0
    v_mov_b32 v52, 0
    v_mov_b32 v53, 0
    v_mov_b32 v54, 0
    v_mov_b32 v55, 0

    s_waitcnt lgkmcnt(0)
    s_mul_i32 s56, s56, 2654435761
    s_add_u32 s56, s56, 2135587861

    s_bfe_u32 s57, s56, 524288
    s_bfe_u32 s58, s56, 524296
    s_bfe_u32 s59, s56, 524304
    s_bfe_u32 s60, s56, 524312

    s_cmp_ge_u32 s97, 5
    s_cbranch_scc1 L_w0a
    s_lshl_b32 s31, s97, 13

    s_cmp_ge_u32 s3, 4
    s_cbranch_scc1 L_wF
    s_waitcnt vmcnt(0)
    s_branch L_j1
    L_w0a:
    s_nop 0
    s_cmp_eq_u32 s3, 6
    s_cbranch_scc1 L_wF6
    s_waitcnt vmcnt(0)
    L_j1:

    v_dot2c_f32_bf16 v48, v38, v128
    v_dot2c_f32_bf16 v49, v43, v128
    v_dot2c_f32_bf16 v50, v38, v129
    v_dot2c_f32_bf16 v51, v43, v129
    v_dot2c_f32_bf16 v52, v38, v130
    v_dot2c_f32_bf16 v53, v43, v130
    v_dot2c_f32_bf16 v54, v38, v131
    v_dot2c_f32_bf16 v55, v43, v131
    v_dot2c_f32_bf16 v48, v39, v132
    v_dot2c_f32_bf16 v49, v44, v132
    v_dot2c_f32_bf16 v50, v39, v133
    v_dot2c_f32_bf16 v51, v44, v133
    v_dot2c_f32_bf16 v52, v39, v134
    v_dot2c_f32_bf16 v53, v44, v134
    v_dot2c_f32_bf16 v54, v39, v135
    v_dot2c_f32_bf16 v55, v44, v135
    v_dot2c_f32_bf16 v48, v40, v136
    v_dot2c_f32_bf16 v49, v45, v136
    v_dot2c_f32_bf16 v50, v40, v137
    v_dot2c_f32_bf16 v51, v45, v137
    v_dot2c_f32_bf16 v52, v40, v138
    v_dot2c_f32_bf16 v53, v45, v138
    v_dot2c_f32_bf16 v54, v40, v139
    v_dot2c_f32_bf16 v55, v45, v139
    v_dot2c_f32_bf16 v48, v41, v140
    v_dot2c_f32_bf16 v49, v46, v140
    v_dot2c_f32_bf16 v50, v41, v141
    v_dot2c_f32_bf16 v51, v46, v141
    v_dot2c_f32_bf16 v52, v41, v142
    v_dot2c_f32_bf16 v53, v46, v142
    v_dot2c_f32_bf16 v54, v41, v143
    v_dot2c_f32_bf16 v55, v46, v143
    v_dot2c_f32_bf16 v48, v42, v144
    v_dot2c_f32_bf16 v49, v47, v144
    v_dot2c_f32_bf16 v50, v42, v145
    v_dot2c_f32_bf16 v51, v47, v145
    v_dot2c_f32_bf16 v52, v42, v146
    v_dot2c_f32_bf16 v53, v47, v146
    v_dot2c_f32_bf16 v54, v42, v147
    v_dot2c_f32_bf16 v55, v47, v147
    v_permlane32_swap_b32 v48, v52
    v_permlane32_swap_b32 v49, v53
    v_permlane32_swap_b32 v50, v54
    v_permlane32_swap_b32 v51, v55
    v_add_f32 v48, v48, v52
    v_add_f32 v49, v49, v53
    v_add_f32 v50, v50, v54
    v_add_f32 v51, v51, v55
    s_nop 0
    v_permlane16_swap_b32 v48, v50
    v_permlane16_swap_b32 v49, v51
    v_add_f32 v48, v48, v50
    v_add_f32 v49, v49, v51

    s_lshl_b32 s30, s3, 9
    v_lshlrev_b32 v10, 5, v3
    v_lshl_add_u32 v10, v4, 3, v10
    v_add_u32 v10, s30, v10
    ds_write_b64 v10, v[48:49] offset:0

    v_mov_b32 v11, 1
    v_mov_b32 v12, 8452
    s_cmp_lg_u32 s3, 0
    s_cbranch_scc1 L_nopub1
    s_mov_b32 s86, 0
    L_c1:
    ds_read_b32 v13, v12
    s_waitcnt lgkmcnt(0)
    v_readfirstlane_b32 s30, v13
    s_nop 0
    s_cmp_ge_u32 s30, 3
    s_cbranch_scc1 L_c1ok
    s_add_u32 s86, s86, 1
    s_cmp_lt_u32 s86, 400000
    s_cbranch_scc1 L_c1
    L_c1ok:
    ds_read_b128 v[16:19], v180 offset:0
    ds_read_b128 v[20:23], v180 offset:512
    s_lshl_b32 s30, s29, 10
    v_add_u32 v10, s30, v2
    s_waitcnt lgkmcnt(0)

    v_add_f32 v16, v16, v20
    v_add_f32 v17, v17, v21
    v_add_f32 v18, v18, v22
    v_add_f32 v19, v19, v23
    v_mov_b32 v20, v16
    v_mov_b32 v21, v17
    v_mov_b32 v22, v18
    v_mov_b32 v23, v19
    v_permlane32_swap_b32 v20, v16
    v_permlane32_swap_b32 v21, v17
    v_permlane32_swap_b32 v22, v18
    v_permlane32_swap_b32 v23, v19
    v_add_f32 v16, v16, v20
    v_add_f32 v17, v17, v21
    v_add_f32 v18, v18, v22
    v_add_f32 v19, v19, v23
    v_and_or_b32 v16, v16, v6, s57
    v_and_or_b32 v17, v17, v6, s58
    v_and_or_b32 v18, v18, v6, s59
    v_and_or_b32 v19, v19, v6, s60
    s_mov_b32 exec_hi, 0
    global_store_dwordx4 v10, v[16:19], s[80:81]
    s_mov_b32 exec_hi, -1
    s_mov_b64 s[0:1], s[80:81]

    global_load_dwordx4 v[64:67], v5, s[0:1] sc1
    global_load_dwordx4 v[68:71], v5, s[0:1] offset:2048 sc1
    global_load_dwordx4 v[72:75], v247, s[0:1] sc1
    global_load_dwordx4 v[76:79], v247, s[0:1] offset:2048 sc1

    v_mov_b32 v108, v16
    v_mov_b32 v109, v17
    v_mov_b32 v110, v18
    v_mov_b32 v111, v19

    s_mov_b32 s75, 0
    s_mov_b32 s86, 0
    s_waitcnt vmcnt(0)
    s_branch L_p1_chk

    s_mov_b32 s86, 0
    L_p1_ld:
    global_load_dwordx4 v[64:67], v5, s[0:1] sc1
    global_load_dwordx4 v[68:71], v5, s[0:1] offset:2048 sc1
    global_load_dwordx4 v[72:75], v247, s[0:1] sc1
    global_load_dwordx4 v[76:79], v247, s[0:1] offset:2048 sc1
    s_waitcnt vmcnt(0)
    L_p1_chk:

    v_perm_b32 v24, v65, v64, s61
    v_perm_b32 v25, v67, v66, s62
    v_perm_b32 v26, v69, v68, s61
    v_perm_b32 v27, v71, v70, s62
    v_perm_b32 v28, v73, v72, s61
    v_perm_b32 v29, v75, v74, s62
    v_perm_b32 v30, v77, v76, s61
    v_perm_b32 v31, v79, v78, s62
    v_or_b32 v24, v24, v25
    v_or_b32 v26, v26, v27
    v_or_b32 v28, v28, v29
    v_or_b32 v30, v30, v31
    v_xor_b32 v24, s56, v24
    v_xor_b32 v26, s56, v26
    v_xor_b32 v28, s56, v28
    v_xor_b32 v30, s56, v30

    v_or_b32 v24, v24, v26
    v_or_b32 v28, v28, v30
    v_or_b32 v24, v24, v28
    v_cmp_ne_u32 vcc, 0, v24
    s_cbranch_vccz L_p1_ok
    s_mov_b64 exec, vcc
    s_add_u32 s86, s86, 1

    s_cmp_lg_u32 s86, 62
    s_cbranch_scc1 L_p1_nf
    s_mov_b64 s[68:69], exec

    s_mov_b32 exec_lo, -1
    s_mov_b32 exec_hi, 0
    global_store_dwordx4 v112, v[108:111], s[24:25] sc1
    s_mov_b32 exec_hi, -1
    s_or_b32 s75, s75, 2

    s_mov_b64 exec, s[68:69]
        L_p1_nf:

    s_and_b32 s31, s86, 63
    s_cmp_eq_u32 s31, 63
    s_cselect_b32 s0, s24, s80
    s_cselect_b32 s1, s25, s81

    s_cmp_lt_u32 s86, s87
    s_cbranch_scc1 L_p1_ld
    L_p1_ok:
    s_mov_b64 exec, -1

    v_and_b32 v64, v64, v6
    v_and_b32 v65, v65, v6
    v_and_b32 v66, v66, v6
    v_and_b32 v67, v67, v6
    v_and_b32 v68, v68, v6
    v_and_b32 v69, v69, v6
    v_and_b32 v70, v70, v6
    v_and_b32 v71, v71, v6
    v_and_b32 v72, v72, v6
    v_and_b32 v73, v73, v6
    v_and_b32 v74, v74, v6
    v_and_b32 v75, v75, v6
    v_and_b32 v76, v76, v6
    v_and_b32 v77, v77, v6
    v_and_b32 v78, v78, v6
    v_and_b32 v79, v79, v6
    v_add_f32 v64, v64, v72
    v_add_f32 v65, v65, v73
    v_add_f32 v66, v66, v74
    v_add_f32 v67, v67, v75
    v_add_f32 v68, v68, v76
    v_add_f32 v69, v69, v77
    v_add_f32 v70, v70, v78
    v_add_f32 v71, v71, v79
    v_add_f32 v64, v64, v68
    v_add_f32 v65, v65, v69
    v_add_f32 v66, v66, v70
    v_add_f32 v67, v67, v71
    v_permlane32_swap_b32 v64, v68
    v_permlane32_swap_b32 v65, v69
    v_permlane32_swap_b32 v66, v70
    v_permlane32_swap_b32 v67, v71
    v_add_f32 v64, v64, v68
    v_add_f32 v65, v65, v69
    v_add_f32 v66, v66, v70
    v_add_f32 v67, v67, v71

    v_cvt_pk_bf16_f32 v16, v64, v65
    v_cvt_pk_bf16_f32 v17, v66, v67
    v_lshlrev_b32 v10, 3, v1
    v_mov_b32 v11, 1
    v_mov_b32 v12, 8448
    s_mov_b32 exec_hi, 0
    ds_write_b64 v10, v[16:17] offset:8192
    s_mov_b32 exec_hi, -1
    ds_write_b32 v12, v11

    s_lshl_b32 s30, s28, 10
    s_add_u32 s30, s30, 2883584
    s_add_u32 s94, s26, s30
    s_addc_u32 s95, s27, 0
    s_add_u32 s84, s94, 65536
    s_addc_u32 s85, s95, 0
    v_and_b32 v14, 7, v1
    v_lshlrev_b32 v15, 7, v14
    v_lshlrev_b32 v14, 3, v14
    v_mov_b32 v12, 8460
    s_mov_b32 s86, 0
    L_c3:
    ds_read_b32 v13, v12
    s_waitcnt lgkmcnt(0)
    v_readfirstlane_b32 s30, v13
    s_nop 0
    s_cmp_ge_u32 s30, 5
    s_cbranch_scc1 L_c3ok
    s_add_u32 s86, s86, 1
    s_cmp_lt_u32 s86, 2000000
    s_cbranch_scc1 L_c3
    L_c3ok:
    ds_read_b64 v[16:17], v14 offset:8512
    s_mov_b32 s68, 0x3e3e3e3e
    s_mov_b32 s69, 0x3e3e3e3e
    v_mov_b32 v18, 0xff800000
    s_waitcnt lgkmcnt(0)
    v_cndmask_b32 v16, v18, v16, s[68:69]
    v_cndmask_b32 v17, 0, v17, s[68:69]
    v_mov_b32 v100, v16

    s_nop 1
    v_max_f32_dpp v100, v100, v100 quad_perm:[1,0,3,2] row_mask:0xf bank_mask:0xf
    s_nop 1
    v_max_f32_dpp v100, v100, v100 quad_perm:[2,3,0,1] row_mask:0xf bank_mask:0xf
    s_nop 1
    v_max_f32_dpp v100, v100, v100 row_half_mirror row_mask:0xf bank_mask:0xf

    v_and_b32 v100, v100, v6
    v_sub_f32 v16, v16, v100
    v_mul_f32 v16, 1069066811, v16
    v_exp_f32 v16, v16
    s_nop 0
    v_mul_f32 v101, v16, v17

    s_nop 1
    v_add_f32_dpp v101, v101, v101 quad_perm:[1,0,3,2] row_mask:0xf bank_mask:0xf
    s_nop 1
    v_add_f32_dpp v101, v101, v101 quad_perm:[2,3,0,1] row_mask:0xf bank_mask:0xf
    s_nop 1
    v_add_f32_dpp v101, v101, v101 row_half_mirror row_mask:0xf bank_mask:0xf

    v_mov_b32 v102, 0
    v_mov_b32 v103, 0

    v_and_or_b32 v100, v100, v6, s57
    v_and_or_b32 v101, v101, v6, s58
    v_and_or_b32 v102, v102, v6, s59
    v_and_or_b32 v103, v103, v6, s60

    s_mov_b64 exec, 1
    global_store_dwordx4 v104, v[100:103], s[94:95]
    s_mov_b64 exec, -1

    s_mov_b64 s[0:1], s[94:95]

    s_mov_b32 s86, 0
    L_st_ld:
    global_load_dwordx4 v[16:19], v15, s[0:1] sc1
    s_waitcnt vmcnt(0)

    v_perm_b32 v10, v17, v16, s61
    v_perm_b32 v11, v19, v18, s62
    v_or_b32 v10, v10, v11

    v_cmp_ne_u32 vcc, s56, v10
    s_cbranch_vccz L_st_ok
    s_add_u32 s86, s86, 1
    s_cmp_lg_u32 s86, 16
    s_cbranch_scc1 L_st_nx
    s_mov_b64 exec, 1
    global_store_dwordx4 v104, v[100:103], s[84:85] sc1
    s_mov_b64 exec, -1
    s_or_b32 s75, s75, 1
    s_bitcmp1_b32 s75, 1
    s_cbranch_scc1 L_st_nx

    s_mov_b32 exec_lo, -1
    s_mov_b32 exec_hi, 0
    global_store_dwordx4 v112, v[108:111], s[24:25] sc1
    s_mov_b32 exec_hi, -1
    s_or_b32 s75, s75, 2

    L_st_nx:
    s_and_b32 s31, s86, 15
    s_cmp_eq_u32 s31, 15
    s_cselect_b32 s0, s84, s94
    s_cselect_b32 s1, s85, s95
    s_cmp_lt_u32 s86, s87
    s_cbranch_scc1 L_st_ld
    L_st_ok:
    v_and_b32 v16, v16, v6
    v_and_b32 v17, v17, v6
    v_mov_b32 v20, v16

    s_nop 1
    v_max_f32_dpp v20, v20, v20 quad_perm:[1,0,3,2] row_mask:0xf bank_mask:0xf
    s_nop 1
    v_max_f32_dpp v20, v20, v20 quad_perm:[2,3,0,1] row_mask:0xf bank_mask:0xf
    s_nop 1
    v_max_f32_dpp v20, v20, v20 row_half_mirror row_mask:0xf bank_mask:0xf

    v_sub_f32 v16, v16, v20
    v_mul_f32 v16, 1069066811, v16
    v_exp_f32 v16, v16
    s_nop 0
    v_mul_f32 v21, v16, v17

    s_nop 1
    v_add_f32_dpp v21, v21, v21 quad_perm:[1,0,3,2] row_mask:0xf bank_mask:0xf
    s_nop 1
    v_add_f32_dpp v21, v21, v21 quad_perm:[2,3,0,1] row_mask:0xf bank_mask:0xf
    s_nop 1
    v_add_f32_dpp v21, v21, v21 row_half_mirror row_mask:0xf bank_mask:0xf

    v_rcp_f32 v21, v21
    v_mov_b32 v10, 8472
    v_mov_b32 v11, 1
    v_mov_b32 v12, 8464
    s_mov_b64 exec, 1
    ds_write_b64 v10, v[20:21]
    ds_write_b32 v12, v11
    s_mov_b64 exec, -1
    s_branch L_barC
    L_nopub1:
    s_mov_b64 exec, 1
    ds_add_u32 v12, v11
    s_mov_b64 exec, -1
    s_branch L_cons
    L_wF6:
    s_cmp_eq_u32 s71, 0
    s_cbranch_scc1 L_barC

    v_add_u32 v84, 40, v62
    v_add_u32 v85, 48, v62
    v_add_u32 v86, 56, v62
    v_add_u32 v87, 64, v62
    v_add_u32 v88, 72, v62
    ds_read_u16 v89, v84 offset:10240
    ds_read_u16 v90, v85 offset:10240
    ds_read_u16 v91, v86 offset:10240
    ds_read_u16 v92, v87 offset:10240
    ds_read_u16 v93, v88 offset:10240
    s_waitcnt lgkmcnt(0)
    v_lshlrev_b32 v89, 16, v89
    v_lshlrev_b32 v90, 16, v90
    v_lshlrev_b32 v91, 16, v91
    v_lshlrev_b32 v92, 16, v92
    v_lshlrev_b32 v93, 16, v93
    v_sub_f32 v89, v89, v29
    v_sub_f32 v90, v90, v29
    v_sub_f32 v91, v91, v29
    v_sub_f32 v92, v92, v29
    v_sub_f32 v93, v93, v29
    v_cvt_pk_bf16_f32 v89, 0, v89
    v_cvt_pk_bf16_f32 v90, 0, v90
    v_cvt_pk_bf16_f32 v91, 0, v91
    v_cvt_pk_bf16_f32 v92, 0, v92
    v_cvt_pk_bf16_f32 v93, 0, v93
    v_mul_f32 v89, v89, v30
    v_mul_f32 v90, v90, v30
    v_mul_f32 v91, v91, v30
    v_mul_f32 v92, v92, v30
    v_mul_f32 v93, v93, v30
    v_cvt_pk_bf16_f32 v89, 0, v89
    v_cvt_pk_bf16_f32 v90, 0, v90
    v_cvt_pk_bf16_f32 v91, 0, v91
    v_cvt_pk_bf16_f32 v92, 0, v92
    v_cvt_pk_bf16_f32 v93, 0, v93
    v_lshrrev_b32 v84, 16, v89
    v_lshrrev_b32 v85, 16, v90
    v_lshrrev_b32 v86, 16, v91
    v_lshrrev_b32 v87, 16, v92
    v_lshrrev_b32 v88, 16, v93
    s_waitcnt vmcnt(0)
    v_dot2c_f32_bf16 v48, v38, v128
    v_dot2c_f32_bf16 v49, v43, v128
    v_dot2c_f32_bf16 v50, v38, v129
    v_dot2c_f32_bf16 v51, v43, v129
    v_dot2c_f32_bf16 v52, v38, v130
    v_dot2c_f32_bf16 v53, v43, v130
    v_dot2c_f32_bf16 v54, v38, v131
    v_dot2c_f32_bf16 v55, v43, v131
    v_dot2c_f32_bf16 v48, v39, v132
    v_dot2c_f32_bf16 v49, v44, v132
    v_dot2c_f32_bf16 v50, v39, v133
    v_dot2c_f32_bf16 v51, v44, v133
    v_dot2c_f32_bf16 v52, v39, v134
    v_dot2c_f32_bf16 v53, v44, v134
    v_dot2c_f32_bf16 v54, v39, v135
    v_dot2c_f32_bf16 v55, v44, v135
    v_dot2c_f32_bf16 v48, v40, v136
    v_dot2c_f32_bf16 v49, v45, v136
    v_dot2c_f32_bf16 v50, v40, v137
    v_dot2c_f32_bf16 v51, v45, v137
    v_dot2c_f32_bf16 v52, v40, v138
    v_dot2c_f32_bf16 v53, v45, v138
    v_dot2c_f32_bf16 v54, v40, v139
    v_dot2c_f32_bf16 v55, v45, v139
    v_dot2c_f32_bf16 v48, v41, v140
    v_dot2c_f32_bf16 v49, v46, v140
    v_dot2c_f32_bf16 v50, v41, v141
    v_dot2c_f32_bf16 v51, v46, v141
    v_dot2c_f32_bf16 v52, v41, v142
    v_dot2c_f32_bf16 v53, v46, v142
    v_dot2c_f32_bf16 v54, v41, v143
    v_dot2c_f32_bf16 v55, v46, v143
    v_dot2c_f32_bf16 v48, v42, v144
    v_dot2c_f32_bf16 v49, v47, v144
    v_dot2c_f32_bf16 v50, v42, v145
    v_dot2c_f32_bf16 v51, v47, v145
    v_dot2c_f32_bf16 v52, v42, v146
    v_dot2c_f32_bf16 v53, v47, v146
    v_dot2c_f32_bf16 v54, v42, v147
    v_dot2c_f32_bf16 v55, v47, v147
    buffer_load_dwordx4 v[128:131], v7, s[40:43], s75 offen nt
    s_add_u32 s75, s75, 13824
    buffer_load_dwordx4 v[132:135], v7, s[40:43], s75 offen nt
    s_add_u32 s75, s75, 13824
    buffer_load_dwordx4 v[136:139], v7, s[40:43], s75 offen nt
    s_add_u32 s75, s75, 13824
    buffer_load_dwordx4 v[140:143], v7, s[40:43], s75 offen nt
    s_add_u32 s75, s75, 13824
    buffer_load_dwordx4 v[144:147], v7, s[40:43], s75 offen nt
    s_add_u32 s75, s75, 13824
    v_dot2c_f32_bf16 v48, v84, v64
    v_dot2c_f32_bf16 v49, v89, v64
    v_dot2c_f32_bf16 v50, v84, v65
    v_dot2c_f32_bf16 v51, v89, v65
    v_dot2c_f32_bf16 v52, v84, v66
    v_dot2c_f32_bf16 v53, v89, v66
    v_dot2c_f32_bf16 v54, v84, v67
    v_dot2c_f32_bf16 v55, v89, v67
    v_dot2c_f32_bf16 v48, v85, v68
    v_dot2c_f32_bf16 v49, v90, v68
    v_dot2c_f32_bf16 v50, v85, v69
    v_dot2c_f32_bf16 v51, v90, v69
    v_dot2c_f32_bf16 v52, v85, v70
    v_dot2c_f32_bf16 v53, v90, v70
    v_dot2c_f32_bf16 v54, v85, v71
    v_dot2c_f32_bf16 v55, v90, v71
    v_dot2c_f32_bf16 v48, v86, v72
    v_dot2c_f32_bf16 v49, v91, v72
    v_dot2c_f32_bf16 v50, v86, v73
    v_dot2c_f32_bf16 v51, v91, v73
    v_dot2c_f32_bf16 v52, v86, v74
    v_dot2c_f32_bf16 v53, v91, v74
    v_dot2c_f32_bf16 v54, v86, v75
    v_dot2c_f32_bf16 v55, v91, v75
    v_dot2c_f32_bf16 v48, v87, v76
    v_dot2c_f32_bf16 v49, v92, v76
    v_dot2c_f32_bf16 v50, v87, v77
    v_dot2c_f32_bf16 v51, v92, v77
    v_dot2c_f32_bf16 v52, v87, v78
    v_dot2c_f32_bf16 v53, v92, v78
    v_dot2c_f32_bf16 v54, v87, v79
    v_dot2c_f32_bf16 v55, v92, v79
    v_dot2c_f32_bf16 v48, v88, v80
    v_dot2c_f32_bf16 v49, v93, v80
    v_dot2c_f32_bf16 v50, v88, v81
    v_dot2c_f32_bf16 v51, v93, v81
    v_dot2c_f32_bf16 v52, v88, v82
    v_dot2c_f32_bf16 v53, v93, v82
    v_dot2c_f32_bf16 v54, v88, v83
    v_dot2c_f32_bf16 v55, v93, v83
    buffer_load_dwordx4 v[64:67], v7, s[40:43], s75 offen nt
    s_add_u32 s75, s75, 13824
    buffer_load_dwordx4 v[68:71], v7, s[40:43], s75 offen nt
    s_add_u32 s75, s75, 13824
    buffer_load_dwordx4 v[72:75], v7, s[40:43], s75 offen nt
    s_add_u32 s75, s75, 13824
    buffer_load_dwordx4 v[76:79], v7, s[40:43], s75 offen nt
    s_add_u32 s75, s75, 13824
    buffer_load_dwordx4 v[80:83], v7, s[40:43], s75 offen nt
    s_add_u32 s75, s75, 13824
    v_add_u32 v38, 80, v62
    v_add_u32 v39, 88, v62
    v_add_u32 v40, 96, v62
    v_add_u32 v41, 104, v62
    v_add_u32 v42, 112, v62
    ds_read_u16 v43, v38 offset:10240
    ds_read_u16 v44, v39 offset:10240
    ds_read_u16 v45, v40 offset:10240
    ds_read_u16 v46, v41 offset:10240
    ds_read_u16 v47, v42 offset:10240
    s_waitcnt lgkmcnt(0)
    v_lshlrev_b32 v43, 16, v43
    v_lshlrev_b32 v44, 16, v44
    v_lshlrev_b32 v45, 16, v45
    v_lshlrev_b32 v46, 16, v46
    v_lshlrev_b32 v47, 16, v47
    v_sub_f32 v43, v43, v29
    v_sub_f32 v44, v44, v29
    v_sub_f32 v45, v45, v29
    v_sub_f32 v46, v46, v29
    v_sub_f32 v47, v47, v29
    v_cvt_pk_bf16_f32 v43, 0, v43
    v_cvt_pk_bf16_f32 v44, 0, v44
    v_cvt_pk_bf16_f32 v45, 0, v45
    v_cvt_pk_bf16_f32 v46, 0, v46
    v_cvt_pk_bf16_f32 v47, 0, v47
    v_mul_f32 v43, v43, v30
    v_mul_f32 v44, v44, v30
    v_mul_f32 v45, v45, v30
    v_mul_f32 v46, v46, v30
    v_mul_f32 v47, v47, v30
    v_cvt_pk_bf16_f32 v43, 0, v43
    v_cvt_pk_bf16_f32 v44, 0, v44
    v_cvt_pk_bf16_f32 v45, 0, v45
    v_cvt_pk_bf16_f32 v46, 0, v46
    v_cvt_pk_bf16_f32 v47, 0, v47
    v_lshrrev_b32 v38, 16, v43
    v_lshrrev_b32 v39, 16, v44
    v_lshrrev_b32 v40, 16, v45
    v_lshrrev_b32 v41, 16, v46
    v_lshrrev_b32 v42, 16, v47
    v_add_u32 v62, 80, v62

    L_wF:
    s_cmp_eq_u32 s71, 0
    s_cbranch_scc1 L_cons

    v_add_u32 v84, 40, v62
    v_add_u32 v85, 48, v62
    v_add_u32 v86, 56, v62
    v_add_u32 v87, 64, v62
    v_add_u32 v88, 72, v62
    ds_read_u16 v89, v84 offset:10240
    ds_read_u16 v90, v85 offset:10240
    ds_read_u16 v91, v86 offset:10240
    ds_read_u16 v92, v87 offset:10240
    ds_read_u16 v93, v88 offset:10240
    s_waitcnt lgkmcnt(0)
    v_lshlrev_b32 v89, 16, v89
    v_lshlrev_b32 v90, 16, v90
    v_lshlrev_b32 v91, 16, v91
    v_lshlrev_b32 v92, 16, v92
    v_lshlrev_b32 v93, 16, v93
    v_sub_f32 v89, v89, v29
    v_sub_f32 v90, v90, v29
    v_sub_f32 v91, v91, v29
    v_sub_f32 v92, v92, v29
    v_sub_f32 v93, v93, v29
    v_cvt_pk_bf16_f32 v89, 0, v89
    v_cvt_pk_bf16_f32 v90, 0, v90
    v_cvt_pk_bf16_f32 v91, 0, v91
    v_cvt_pk_bf16_f32 v92, 0, v92
    v_cvt_pk_bf16_f32 v93, 0, v93
    v_mul_f32 v89, v89, v30
    v_mul_f32 v90, v90, v30
    v_mul_f32 v91, v91, v30
    v_mul_f32 v92, v92, v30
    v_mul_f32 v93, v93, v30
    v_cvt_pk_bf16_f32 v89, 0, v89
    v_cvt_pk_bf16_f32 v90, 0, v90
    v_cvt_pk_bf16_f32 v91, 0, v91
    v_cvt_pk_bf16_f32 v92, 0, v92
    v_cvt_pk_bf16_f32 v93, 0, v93
    v_lshrrev_b32 v84, 16, v89
    v_lshrrev_b32 v85, 16, v90
    v_lshrrev_b32 v86, 16, v91
    v_lshrrev_b32 v87, 16, v92
    v_lshrrev_b32 v88, 16, v93

    s_cmp_eq_u32 s3, 6
    s_cbranch_scc1 L_wF6b
    s_waitcnt vmcnt(0)
    s_branch L_wFd
    L_wF6b:
    s_waitcnt vmcnt(0)
    L_wFd:

    v_dot2c_f32_bf16 v48, v38, v128
    v_dot2c_f32_bf16 v49, v43, v128
    v_dot2c_f32_bf16 v50, v38, v129
    v_dot2c_f32_bf16 v51, v43, v129
    v_dot2c_f32_bf16 v52, v38, v130
    v_dot2c_f32_bf16 v53, v43, v130
    v_dot2c_f32_bf16 v54, v38, v131
    v_dot2c_f32_bf16 v55, v43, v131
    v_dot2c_f32_bf16 v48, v39, v132
    v_dot2c_f32_bf16 v49, v44, v132
    v_dot2c_f32_bf16 v50, v39, v133
    v_dot2c_f32_bf16 v51, v44, v133
    v_dot2c_f32_bf16 v52, v39, v134
    v_dot2c_f32_bf16 v53, v44, v134
    v_dot2c_f32_bf16 v54, v39, v135
    v_dot2c_f32_bf16 v55, v44, v135
    v_dot2c_f32_bf16 v48, v40, v136
    v_dot2c_f32_bf16 v49, v45, v136
    v_dot2c_f32_bf16 v50, v40, v137
    v_dot2c_f32_bf16 v51, v45, v137
    v_dot2c_f32_bf16 v52, v40, v138
    v_dot2c_f32_bf16 v53, v45, v138
    v_dot2c_f32_bf16 v54, v40, v139
    v_dot2c_f32_bf16 v55, v45, v139
    v_dot2c_f32_bf16 v48, v41, v140
    v_dot2c_f32_bf16 v49, v46, v140
    v_dot2c_f32_bf16 v50, v41, v141
    v_dot2c_f32_bf16 v51, v46, v141
    v_dot2c_f32_bf16 v52, v41, v142
    v_dot2c_f32_bf16 v53, v46, v142
    v_dot2c_f32_bf16 v54, v41, v143
    v_dot2c_f32_bf16 v55, v46, v143
    v_dot2c_f32_bf16 v48, v42, v144
    v_dot2c_f32_bf16 v49, v47, v144
    v_dot2c_f32_bf16 v50, v42, v145
    v_dot2c_f32_bf16 v51, v47, v145
    v_dot2c_f32_bf16 v52, v42, v146
    v_dot2c_f32_bf16 v53, v47, v146
    v_dot2c_f32_bf16 v54, v42, v147
    v_dot2c_f32_bf16 v55, v47, v147
    v_dot2c_f32_bf16 v48, v84, v64
    v_dot2c_f32_bf16 v49, v89, v64
    v_dot2c_f32_bf16 v50, v84, v65
    v_dot2c_f32_bf16 v51, v89, v65
    v_dot2c_f32_bf16 v52, v84, v66
    v_dot2c_f32_bf16 v53, v89, v66
    v_dot2c_f32_bf16 v54, v84, v67
    v_dot2c_f32_bf16 v55, v89, v67
    v_dot2c_f32_bf16 v48, v85, v68
    v_dot2c_f32_bf16 v49, v90, v68
    v_dot2c_f32_bf16 v50, v85, v69
    v_dot2c_f32_bf16 v51, v90, v69
    v_dot2c_f32_bf16 v52, v85, v70
    v_dot2c_f32_bf16 v53, v90, v70
    v_dot2c_f32_bf16 v54, v85, v71
    v_dot2c_f32_bf16 v55, v90, v71
    v_dot2c_f32_bf16 v48, v86, v72
    v_dot2c_f32_bf16 v49, v91, v72
    v_dot2c_f32_bf16 v50, v86, v73
    v_dot2c_f32_bf16 v51, v91, v73
    v_dot2c_f32_bf16 v52, v86, v74
    v_dot2c_f32_bf16 v53, v91, v74
    v_dot2c_f32_bf16 v54, v86, v75
    v_dot2c_f32_bf16 v55, v91, v75
    v_dot2c_f32_bf16 v48, v87, v76
    v_dot2c_f32_bf16 v49, v92, v76
    v_dot2c_f32_bf16 v50, v87, v77
    v_dot2c_f32_bf16 v51, v92, v77
    v_dot2c_f32_bf16 v52, v87, v78
    v_dot2c_f32_bf16 v53, v92, v78
    v_dot2c_f32_bf16 v54, v87, v79
    v_dot2c_f32_bf16 v55, v92, v79
    v_dot2c_f32_bf16 v48, v88, v80
    v_dot2c_f32_bf16 v49, v93, v80
    v_dot2c_f32_bf16 v50, v88, v81
    v_dot2c_f32_bf16 v51, v93, v81
    v_dot2c_f32_bf16 v52, v88, v82
    v_dot2c_f32_bf16 v53, v93, v82
    v_dot2c_f32_bf16 v54, v88, v83
    v_dot2c_f32_bf16 v55, v93, v83
    v_permlane32_swap_b32 v48, v52
    v_permlane32_swap_b32 v49, v53
    v_permlane32_swap_b32 v50, v54
    v_permlane32_swap_b32 v51, v55
    v_add_f32 v48, v48, v52
    v_add_f32 v49, v49, v53
    v_add_f32 v50, v50, v54
    v_add_f32 v51, v51, v55
    s_nop 0
    v_permlane16_swap_b32 v48, v50
    v_permlane16_swap_b32 v49, v51
    v_add_f32 v48, v48, v50
    v_add_f32 v49, v49, v51

    s_lshl_b32 s30, s3, 9
    v_lshlrev_b32 v10, 5, v3
    v_lshl_add_u32 v10, v4, 3, v10
    v_add_u32 v10, s30, v10
    ds_write_b64 v10, v[48:49] offset:0

    v_mov_b32 v11, 1
    v_mov_b32 v12, 8456
    s_mov_b64 exec, 1
    ds_add_rtn_u32 v13, v12, v11
    s_mov_b64 exec, -1
    s_waitcnt lgkmcnt(0)
    v_readfirstlane_b32 s30, v13
    s_nop 0
    s_cmp_lg_u32 s30, 2
    s_cbranch_scc1 L_nopubF

    ds_read_b128 v[16:19], v180 offset:2048
    ds_read_b128 v[20:23], v180 offset:2560
    s_lshl_b32 s30, s29, 10
    v_add_u32 v10, s30, v2
    s_waitcnt lgkmcnt(0)
    s_mov_b32 exec_hi, 0

    v_add_f32 v16, v16, v20
    v_add_f32 v17, v17, v21
    v_add_f32 v18, v18, v22
    v_add_f32 v19, v19, v23
    s_mov_b32 exec_hi, -1
    v_and_or_b32 v16, v16, v6, s57
    v_and_or_b32 v17, v17, v6, s58
    v_and_or_b32 v18, v18, v6, s59
    v_and_or_b32 v19, v19, v6, s60
    global_store_dwordx4 v10, v[16:19], s[94:95]

    L_nopubF:
    s_nop 0
    s_cmp_eq_u32 s3, 6
    s_cbranch_scc1 L_barC
    s_branch L_cons
    L_loader:
    s_mov_b32 s78, 0

    s_lshl_b32 s30, s78, 8
    s_add_u32 s30, s30, 8704
    v_lshl_add_u32 v33, v1, 2, s30
    s_mov_b32 s73, 5
    s_add_u32 s72, s78, 5
    s_add_u32 s30, s78, 5
    s_lshl_b32 s74, s30, 13
    s_add_u32 s74, s74, 16384
    s_lshl_b32 s30, s30, 2
    s_add_u32 s30, s30, 9216
    v_mov_b32 v35, s30
    ds_read_b32 v10, v35

    s_add_u32 s75, s72, 0
    s_lshl_b32 s75, s75, 13

    L_ldK:
    s_cmp_ge_u32 s72, 32
    s_cbranch_scc1 L_ldV0

    s_sub_u32 s76, s72, 17
    s_mov_b32 s86, 0
        L_fsK:
    s_waitcnt lgkmcnt(0)
    v_readfirstlane_b32 s30, v10
    s_nop 0
    s_cmp_ge_i32 s30, s76
    s_cbranch_scc1 L_foK
    ds_read_b32 v10, v35
    s_add_u32 s86, s86, 1
    s_cmp_lt_u32 s86, 400000
    s_cbranch_scc1 L_fsK
        L_foK:

    s_mov_b32 m0, s74
    s_add_u32 s31, s74, 4096

    buffer_load_dwordx4 v2, s[32:35], s75 offen offset:0 nt lds
    buffer_load_dwordx4 v2, s[32:35], s75 offen offset:1024 nt lds
    buffer_load_dwordx4 v2, s[32:35], s75 offen offset:2048 nt lds
    buffer_load_dwordx4 v2, s[32:35], s75 offen offset:3072 nt lds

    s_add_u32 s74, s74, 8192
    s_cmp_ge_u32 s74, 163840
    s_cselect_b32 s30, 147456, 0
    s_sub_u32 s74, s74, s30
    s_sub_u32 s30, s74, 16384
    s_lshr_b32 s30, s30, 11
    s_add_u32 s30, s30, 9216
    v_mov_b32 v35, s30

    s_waitcnt vmcnt(40)

    s_mov_b32 m0, s31
    s_add_u32 s75, s75, 4096

    buffer_load_dwordx4 v2, s[32:35], s75 offen offset:0 nt lds
    buffer_load_dwordx4 v2, s[32:35], s75 offen offset:1024 nt lds
    buffer_load_dwordx4 v2, s[32:35], s75 offen offset:2048 nt lds
    buffer_load_dwordx4 v2, s[32:35], s75 offen offset:3072 nt lds

    ds_read_b32 v10, v35
    s_add_u32 s75, s75, 4096
    s_add_u32 s73, s73, 1
    s_add_u32 s72, s72, 1

    s_waitcnt vmcnt(40)
    s_sub_u32 s30, s73, 5
    s_max_i32 s78, s78, s30
    v_mov_b32 v34, s78
    ds_write_b32 v33, v34

    s_branch L_ldK
    L_ldV0:
    s_sub_u32 s75, s72, 32
    s_lshl_b32 s75, s75, 13

L_ldV:

    s_sub_u32 s76, s72, 17
    s_mov_b32 s86, 0
        L_fsV:
    s_waitcnt lgkmcnt(0)
    v_readfirstlane_b32 s30, v10
    s_nop 0
    s_cmp_ge_i32 s30, s76
    s_cbranch_scc1 L_foV
    ds_read_b32 v10, v35
    s_add_u32 s86, s86, 1
    s_cmp_lt_u32 s86, 400000
    s_cbranch_scc1 L_fsV
        L_foV:

    s_mov_b32 m0, s74
    s_add_u32 s31, s74, 4096

    buffer_load_dwordx4 v2, s[36:39], s75 offen offset:0 nt lds
    buffer_load_dwordx4 v2, s[36:39], s75 offen offset:1024 nt lds
    buffer_load_dwordx4 v2, s[36:39], s75 offen offset:2048 nt lds
    buffer_load_dwordx4 v2, s[36:39], s75 offen offset:3072 nt lds

    s_add_u32 s74, s74, 8192
    s_cmp_ge_u32 s74, 163840
    s_cselect_b32 s30, 147456, 0
    s_sub_u32 s74, s74, s30
    s_sub_u32 s30, s74, 16384
    s_lshr_b32 s30, s30, 11
    s_add_u32 s30, s30, 9216
    v_mov_b32 v35, s30

    s_waitcnt vmcnt(40)

    s_mov_b32 m0, s31
    s_add_u32 s75, s75, 4096

    buffer_load_dwordx4 v2, s[36:39], s75 offen offset:0 nt lds
    buffer_load_dwordx4 v2, s[36:39], s75 offen offset:1024 nt lds
    buffer_load_dwordx4 v2, s[36:39], s75 offen offset:2048 nt lds
    buffer_load_dwordx4 v2, s[36:39], s75 offen offset:3072 nt lds

    ds_read_b32 v10, v35
    s_add_u32 s75, s75, 4096
    s_add_u32 s73, s73, 1
    s_add_u32 s72, s72, 1

    s_waitcnt vmcnt(40)
    s_sub_u32 s30, s73, 5
    s_max_i32 s78, s78, s30
    v_mov_b32 v34, s78
    ds_write_b32 v33, v34

    s_cmp_lt_u32 s72, 64
    s_cbranch_scc1 L_ldV

    s_waitcnt vmcnt(32)
    s_sub_u32 s30, s73, 4
    s_max_i32 s78, s78, s30
    v_mov_b32 v34, s78
    ds_write_b32 v33, v34
    s_waitcnt vmcnt(24)
    s_sub_u32 s30, s73, 3
    s_max_i32 s78, s78, s30
    v_mov_b32 v34, s78
    ds_write_b32 v33, v34
    s_waitcnt vmcnt(16)
    s_sub_u32 s30, s73, 2
    s_max_i32 s78, s78, s30
    v_mov_b32 v34, s78
    ds_write_b32 v33, v34
    s_waitcnt vmcnt(8)
    s_sub_u32 s30, s73, 1
    s_max_i32 s78, s78, s30
    v_mov_b32 v34, s78
    ds_write_b32 v33, v34
    s_waitcnt vmcnt(0)
    s_sub_u32 s30, s73, 0
    s_max_i32 s78, s78, s30
    v_mov_b32 v34, s78
    ds_write_b32 v33, v34

    s_load_dword s56, s[26:27], 0
    s_waitcnt lgkmcnt(0)
    s_mul_i32 s56, s56, 2654435761
    s_add_u32 s56, s56, 2135587861

    s_bfe_u32 s57, s56, 524288
    s_bfe_u32 s58, s56, 524296
    s_bfe_u32 s59, s56, 524304
    s_bfe_u32 s60, s56, 524312

    s_branch L_barC

    L_cons:

    buffer_load_dwordx4 v[224:227], v8, s[48:51], 0 offen offset:0 nt
    buffer_load_dwordx4 v[228:231], v8, s[48:51], 0 offen offset:1280 nt
    buffer_load_dwordx4 v[232:235], v8, s[48:51], 0 offen offset:2560 nt
    buffer_load_dwordx4 v[236:239], v8, s[48:51], 0 offen offset:3840 nt
    buffer_load_dwordx4 v[148:151], v8, s[44:47], 0 offen offset:0 nt
    buffer_load_dwordx4 v[152:155], v8, s[44:47], 0 offen offset:1280 nt
    buffer_load_dwordx4 v[156:159], v8, s[44:47], 0 offen offset:2560 nt
    buffer_load_dwordx4 v[160:163], v8, s[44:47], 0 offen offset:3840 nt

    v_mov_b32 v12, 8448
    v_lshlrev_b32 v11, 4, v3
    v_mov_b32 v42, 0xff800000
    s_mov_b32 s86, 0
    L_q_ld:
    ds_read_b32 v10, v12
    ds_read_b128 v[56:59], v11 offset:8192
    s_waitcnt lgkmcnt(0)
    v_cmp_ne_u32 vcc, 1, v10
    s_cbranch_vccz L_q_ok
    s_add_u32 s86, s86, 1
    s_cmp_lt_u32 s86, 400000
    s_cbranch_scc1 L_q_ld
    L_q_ok:

    s_mov_b32 s72, s97
    s_mov_b32 s31, s72

    s_sub_u32 s30, s31, 18
    s_cmp_ge_u32 s31, 18
    s_cselect_b32 s31, s30, s31

    s_sub_u32 s30, s31, 18
    s_cmp_ge_u32 s31, 18
    s_cselect_b32 s31, s30, s31

    s_sub_u32 s30, s31, 18
    s_cmp_ge_u32 s31, 18
    s_cselect_b32 s31, s30, s31

    s_lshl_b32 s74, s31, 13
    s_add_u32 s74, s74, 16384

    v_mov_b32 v33, 8704
    s_mov_b32 s76, s72

    v_add_u32 v32, s74, v2
    s_mov_b32 s86, 0
        L_lw1:
    ds_read_b32 v10, v33
    s_waitcnt lgkmcnt(0)
    v_readfirstlane_b32 s30, v10
    s_nop 0
    s_cmp_gt_i32 s30, s76
    s_cbranch_scc1 L_lo1
    s_add_u32 s86, s86, 1
    s_cmp_lt_u32 s86, 400000
    s_cbranch_scc1 L_lw1
        L_lo1:

    ds_read_b128 v[64:67], v32 offset:0
    ds_read_b128 v[68:71], v32 offset:1024
    ds_read_b128 v[72:75], v32 offset:2048
    ds_read_b128 v[76:79], v32 offset:3072
    ds_read_b128 v[80:83], v32 offset:4096
    ds_read_b128 v[84:87], v32 offset:5120
    ds_read_b128 v[88:91], v32 offset:6144
    ds_read_b128 v[92:95], v32 offset:7168

    s_sub_u32 s30, s74, 16384
    s_lshr_b32 s30, s30, 11
    s_add_u32 s30, s30, 9216
    v_mov_b32 v35, s30
    s_add_u32 s30, s72, 1
    v_mov_b32 v34, s30

    s_waitcnt lgkmcnt(7)
    v_dot2_f32_bf16 v16, v64, v56, 0
    v_dot2_f32_bf16 v16, v65, v57, v16
    v_dot2_f32_bf16 v16, v66, v58, v16
    v_dot2_f32_bf16 v16, v67, v59, v16
    s_waitcnt lgkmcnt(6)
    v_dot2_f32_bf16 v17, v68, v56, 0
    v_dot2_f32_bf16 v17, v69, v57, v17
    v_dot2_f32_bf16 v17, v70, v58, v17
    v_dot2_f32_bf16 v17, v71, v59, v17
    s_waitcnt lgkmcnt(5)
    v_dot2_f32_bf16 v18, v72, v56, 0
    v_dot2_f32_bf16 v18, v73, v57, v18
    v_dot2_f32_bf16 v18, v74, v58, v18
    v_dot2_f32_bf16 v18, v75, v59, v18
    s_waitcnt lgkmcnt(4)
    v_dot2_f32_bf16 v19, v76, v56, 0
    v_dot2_f32_bf16 v19, v77, v57, v19
    v_dot2_f32_bf16 v19, v78, v58, v19
    v_dot2_f32_bf16 v19, v79, v59, v19
    s_waitcnt lgkmcnt(3)
    v_dot2_f32_bf16 v20, v80, v56, 0
    v_dot2_f32_bf16 v20, v81, v57, v20
    v_dot2_f32_bf16 v20, v82, v58, v20
    v_dot2_f32_bf16 v20, v83, v59, v20
    s_waitcnt lgkmcnt(2)
    v_dot2_f32_bf16 v21, v84, v56, 0
    v_dot2_f32_bf16 v21, v85, v57, v21
    v_dot2_f32_bf16 v21, v86, v58, v21
    v_dot2_f32_bf16 v21, v87, v59, v21
    s_waitcnt lgkmcnt(1)
    v_dot2_f32_bf16 v22, v88, v56, 0
    v_dot2_f32_bf16 v22, v89, v57, v22
    v_dot2_f32_bf16 v22, v90, v58, v22
    v_dot2_f32_bf16 v22, v91, v59, v22
    s_waitcnt lgkmcnt(0)

    s_mov_b64 exec, 1
    ds_write_b32 v35, v34
    s_mov_b64 exec, -1
    s_add_u32 s72, s72, 5
    s_add_u32 s74, s74, 40960
    s_cmp_ge_u32 s74, 163840
    s_cselect_b32 s30, 147456, 0
    s_sub_u32 s74, s74, s30

    v_dot2_f32_bf16 v23, v92, v56, 0
    v_dot2_f32_bf16 v23, v93, v57, v23
    v_dot2_f32_bf16 v23, v94, v58, v23
    v_dot2_f32_bf16 v23, v95, v59, v23
    v_add_f32_dpp v16, v16, v16 row_mirror row_mask:0xf bank_mask:0x3
    v_add_f32_dpp v17, v17, v17 row_mirror row_mask:0xf bank_mask:0x3
    v_add_f32_dpp v18, v18, v18 row_mirror row_mask:0xf bank_mask:0x3
    v_add_f32_dpp v19, v19, v19 row_mirror row_mask:0xf bank_mask:0x3
    v_add_f32_dpp v16, v20, v20 row_mirror row_mask:0xf bank_mask:0xc
    v_add_f32_dpp v17, v21, v21 row_mirror row_mask:0xf bank_mask:0xc
    v_add_f32_dpp v18, v22, v22 row_mirror row_mask:0xf bank_mask:0xc
    v_add_f32_dpp v19, v23, v23 row_mirror row_mask:0xf bank_mask:0xc
    v_add_f32_dpp v16, v16, v16 row_half_mirror row_mask:0xf bank_mask:0x5
    v_add_f32_dpp v17, v17, v17 row_half_mirror row_mask:0xf bank_mask:0x5
    s_nop 0
    v_add_f32_dpp v16, v18, v18 row_half_mirror row_mask:0xf bank_mask:0xa
    v_add_f32_dpp v17, v19, v19 row_half_mirror row_mask:0xf bank_mask:0xa
    s_nop 0
    v_add_f32_dpp v16, v16, v16 quad_perm:[2,3,0,1] row_mask:0xf bank_mask:0xf
    v_add_f32_dpp v17, v17, v17 quad_perm:[2,3,0,1] row_mask:0xf bank_mask:0xf
    v_cndmask_b32 v16, v16, v17, s[64:65]
    s_nop 1
    v_add_f32_dpp v36, v16, v16 quad_perm:[1,0,3,2] row_mask:0xf bank_mask:0xf
    v_cvt_pk_bf16_f32 v36, 0, v36
    v_mul_f32 v36, 1035273459, v36
    v_cvt_pk_bf16_f32 v36, 0, v36

    v_mov_b32 v33, 8704
    s_mov_b32 s76, s72

    v_add_u32 v32, s74, v2
    s_mov_b32 s86, 0
        L_lw2:
    ds_read_b32 v10, v33
    s_waitcnt lgkmcnt(0)
    v_readfirstlane_b32 s30, v10
    s_nop 0
    s_cmp_gt_i32 s30, s76
    s_cbranch_scc1 L_lo2
    s_add_u32 s86, s86, 1
    s_cmp_lt_u32 s86, 400000
    s_cbranch_scc1 L_lw2
        L_lo2:

    ds_read_b128 v[64:67], v32 offset:0
    ds_read_b128 v[68:71], v32 offset:1024
    ds_read_b128 v[72:75], v32 offset:2048
    ds_read_b128 v[76:79], v32 offset:3072
    ds_read_b128 v[80:83], v32 offset:4096
    ds_read_b128 v[84:87], v32 offset:5120
    ds_read_b128 v[88:91], v32 offset:6144
    ds_read_b128 v[92:95], v32 offset:7168

    s_sub_u32 s30, s74, 16384
    s_lshr_b32 s30, s30, 11
    s_add_u32 s30, s30, 9216
    v_mov_b32 v35, s30
    s_add_u32 s30, s72, 1
    v_mov_b32 v34, s30

    s_waitcnt lgkmcnt(7)
    v_dot2_f32_bf16 v16, v64, v56, 0
    v_dot2_f32_bf16 v16, v65, v57, v16
    v_dot2_f32_bf16 v16, v66, v58, v16
    v_dot2_f32_bf16 v16, v67, v59, v16
    s_waitcnt lgkmcnt(6)
    v_dot2_f32_bf16 v17, v68, v56, 0
    v_dot2_f32_bf16 v17, v69, v57, v17
    v_dot2_f32_bf16 v17, v70, v58, v17
    v_dot2_f32_bf16 v17, v71, v59, v17
    s_waitcnt lgkmcnt(5)
    v_dot2_f32_bf16 v18, v72, v56, 0
    v_dot2_f32_bf16 v18, v73, v57, v18
    v_dot2_f32_bf16 v18, v74, v58, v18
    v_dot2_f32_bf16 v18, v75, v59, v18
    s_waitcnt lgkmcnt(4)
    v_dot2_f32_bf16 v19, v76, v56, 0
    v_dot2_f32_bf16 v19, v77, v57, v19
    v_dot2_f32_bf16 v19, v78, v58, v19
    v_dot2_f32_bf16 v19, v79, v59, v19
    s_waitcnt lgkmcnt(3)
    v_dot2_f32_bf16 v20, v80, v56, 0
    v_dot2_f32_bf16 v20, v81, v57, v20
    v_dot2_f32_bf16 v20, v82, v58, v20
    v_dot2_f32_bf16 v20, v83, v59, v20
    s_waitcnt lgkmcnt(2)
    v_dot2_f32_bf16 v21, v84, v56, 0
    v_dot2_f32_bf16 v21, v85, v57, v21
    v_dot2_f32_bf16 v21, v86, v58, v21
    v_dot2_f32_bf16 v21, v87, v59, v21
    s_waitcnt lgkmcnt(1)
    v_dot2_f32_bf16 v22, v88, v56, 0
    v_dot2_f32_bf16 v22, v89, v57, v22
    v_dot2_f32_bf16 v22, v90, v58, v22
    v_dot2_f32_bf16 v22, v91, v59, v22
    s_waitcnt lgkmcnt(0)

    s_mov_b64 exec, 1
    ds_write_b32 v35, v34
    s_mov_b64 exec, -1
    s_add_u32 s72, s72, 5
    s_add_u32 s74, s74, 40960
    s_cmp_ge_u32 s74, 163840
    s_cselect_b32 s30, 147456, 0
    s_sub_u32 s74, s74, s30

    v_dot2_f32_bf16 v23, v92, v56, 0
    v_dot2_f32_bf16 v23, v93, v57, v23
    v_dot2_f32_bf16 v23, v94, v58, v23
    v_dot2_f32_bf16 v23, v95, v59, v23
    v_add_f32_dpp v16, v16, v16 row_mirror row_mask:0xf bank_mask:0x3
    v_add_f32_dpp v17, v17, v17 row_mirror row_mask:0xf bank_mask:0x3
    v_add_f32_dpp v18, v18, v18 row_mirror row_mask:0xf bank_mask:0x3
    v_add_f32_dpp v19, v19, v19 row_mirror row_mask:0xf bank_mask:0x3
    v_add_f32_dpp v16, v20, v20 row_mirror row_mask:0xf bank_mask:0xc
    v_add_f32_dpp v17, v21, v21 row_mirror row_mask:0xf bank_mask:0xc
    v_add_f32_dpp v18, v22, v22 row_mirror row_mask:0xf bank_mask:0xc
    v_add_f32_dpp v19, v23, v23 row_mirror row_mask:0xf bank_mask:0xc
    v_add_f32_dpp v16, v16, v16 row_half_mirror row_mask:0xf bank_mask:0x5
    v_add_f32_dpp v17, v17, v17 row_half_mirror row_mask:0xf bank_mask:0x5
    s_nop 0
    v_add_f32_dpp v16, v18, v18 row_half_mirror row_mask:0xf bank_mask:0xa
    v_add_f32_dpp v17, v19, v19 row_half_mirror row_mask:0xf bank_mask:0xa
    s_nop 0
    v_add_f32_dpp v16, v16, v16 quad_perm:[2,3,0,1] row_mask:0xf bank_mask:0xf
    v_add_f32_dpp v17, v17, v17 quad_perm:[2,3,0,1] row_mask:0xf bank_mask:0xf
    v_cndmask_b32 v16, v16, v17, s[64:65]
    s_nop 1
    v_add_f32_dpp v37, v16, v16 quad_perm:[1,0,3,2] row_mask:0xf bank_mask:0xf
    v_cvt_pk_bf16_f32 v37, 0, v37
    v_mul_f32 v37, 1035273459, v37
    v_cvt_pk_bf16_f32 v37, 0, v37

    v_mov_b32 v33, 8704
    s_mov_b32 s76, s72

    v_add_u32 v32, s74, v2
    s_mov_b32 s86, 0
        L_lw3:
    ds_read_b32 v10, v33
    s_waitcnt lgkmcnt(0)
    v_readfirstlane_b32 s30, v10
    s_nop 0
    s_cmp_gt_i32 s30, s76
    s_cbranch_scc1 L_lo3
    s_add_u32 s86, s86, 1
    s_cmp_lt_u32 s86, 400000
    s_cbranch_scc1 L_lw3
        L_lo3:

    ds_read_b128 v[64:67], v32 offset:0
    ds_read_b128 v[68:71], v32 offset:1024
    ds_read_b128 v[72:75], v32 offset:2048
    ds_read_b128 v[76:79], v32 offset:3072
    ds_read_b128 v[80:83], v32 offset:4096
    ds_read_b128 v[84:87], v32 offset:5120
    ds_read_b128 v[88:91], v32 offset:6144
    ds_read_b128 v[92:95], v32 offset:7168

    s_sub_u32 s30, s74, 16384
    s_lshr_b32 s30, s30, 11
    s_add_u32 s30, s30, 9216
    v_mov_b32 v35, s30
    s_add_u32 s30, s72, 1
    v_mov_b32 v34, s30

    s_waitcnt lgkmcnt(7)
    v_dot2_f32_bf16 v16, v64, v56, 0
    v_dot2_f32_bf16 v16, v65, v57, v16
    v_dot2_f32_bf16 v16, v66, v58, v16
    v_dot2_f32_bf16 v16, v67, v59, v16
    s_waitcnt lgkmcnt(6)
    v_dot2_f32_bf16 v17, v68, v56, 0
    v_dot2_f32_bf16 v17, v69, v57, v17
    v_dot2_f32_bf16 v17, v70, v58, v17
    v_dot2_f32_bf16 v17, v71, v59, v17
    s_waitcnt lgkmcnt(5)
    v_dot2_f32_bf16 v18, v72, v56, 0
    v_dot2_f32_bf16 v18, v73, v57, v18
    v_dot2_f32_bf16 v18, v74, v58, v18
    v_dot2_f32_bf16 v18, v75, v59, v18
    s_waitcnt lgkmcnt(4)
    v_dot2_f32_bf16 v19, v76, v56, 0
    v_dot2_f32_bf16 v19, v77, v57, v19
    v_dot2_f32_bf16 v19, v78, v58, v19
    v_dot2_f32_bf16 v19, v79, v59, v19
    s_waitcnt lgkmcnt(3)
    v_dot2_f32_bf16 v20, v80, v56, 0
    v_dot2_f32_bf16 v20, v81, v57, v20
    v_dot2_f32_bf16 v20, v82, v58, v20
    v_dot2_f32_bf16 v20, v83, v59, v20
    s_waitcnt lgkmcnt(2)
    v_dot2_f32_bf16 v21, v84, v56, 0
    v_dot2_f32_bf16 v21, v85, v57, v21
    v_dot2_f32_bf16 v21, v86, v58, v21
    v_dot2_f32_bf16 v21, v87, v59, v21
    s_waitcnt lgkmcnt(1)
    v_dot2_f32_bf16 v22, v88, v56, 0
    v_dot2_f32_bf16 v22, v89, v57, v22
    v_dot2_f32_bf16 v22, v90, v58, v22
    v_dot2_f32_bf16 v22, v91, v59, v22
    s_waitcnt lgkmcnt(0)

    s_mov_b64 exec, 1
    ds_write_b32 v35, v34
    s_mov_b64 exec, -1
    s_add_u32 s72, s72, 5
    s_add_u32 s74, s74, 40960
    s_cmp_ge_u32 s74, 163840
    s_cselect_b32 s30, 147456, 0
    s_sub_u32 s74, s74, s30

    v_dot2_f32_bf16 v23, v92, v56, 0
    v_dot2_f32_bf16 v23, v93, v57, v23
    v_dot2_f32_bf16 v23, v94, v58, v23
    v_dot2_f32_bf16 v23, v95, v59, v23
    v_add_f32_dpp v16, v16, v16 row_mirror row_mask:0xf bank_mask:0x3
    v_add_f32_dpp v17, v17, v17 row_mirror row_mask:0xf bank_mask:0x3
    v_add_f32_dpp v18, v18, v18 row_mirror row_mask:0xf bank_mask:0x3
    v_add_f32_dpp v19, v19, v19 row_mirror row_mask:0xf bank_mask:0x3
    v_add_f32_dpp v16, v20, v20 row_mirror row_mask:0xf bank_mask:0xc
    v_add_f32_dpp v17, v21, v21 row_mirror row_mask:0xf bank_mask:0xc
    v_add_f32_dpp v18, v22, v22 row_mirror row_mask:0xf bank_mask:0xc
    v_add_f32_dpp v19, v23, v23 row_mirror row_mask:0xf bank_mask:0xc
    v_add_f32_dpp v16, v16, v16 row_half_mirror row_mask:0xf bank_mask:0x5
    v_add_f32_dpp v17, v17, v17 row_half_mirror row_mask:0xf bank_mask:0x5
    s_nop 0
    v_add_f32_dpp v16, v18, v18 row_half_mirror row_mask:0xf bank_mask:0xa
    v_add_f32_dpp v17, v19, v19 row_half_mirror row_mask:0xf bank_mask:0xa
    s_nop 0
    v_add_f32_dpp v16, v16, v16 quad_perm:[2,3,0,1] row_mask:0xf bank_mask:0xf
    v_add_f32_dpp v17, v17, v17 quad_perm:[2,3,0,1] row_mask:0xf bank_mask:0xf
    v_cndmask_b32 v16, v16, v17, s[64:65]
    s_nop 1
    v_add_f32_dpp v38, v16, v16 quad_perm:[1,0,3,2] row_mask:0xf bank_mask:0xf
    v_cvt_pk_bf16_f32 v38, 0, v38
    v_mul_f32 v38, 1035273459, v38
    v_cvt_pk_bf16_f32 v38, 0, v38
    s_cmp_eq_u32 s79, 0
    s_cbranch_scc1 L_nopf
    global_load_dwordx4 v[44:47], v255, s[94:95] sc1
L_nopf:

    v_mov_b32 v33, 8704
    s_mov_b32 s76, s72

    v_add_u32 v32, s74, v2
    s_mov_b32 s86, 0
        L_lw4:
    ds_read_b32 v10, v33
    s_waitcnt lgkmcnt(0)
    v_readfirstlane_b32 s30, v10
    s_nop 0
    s_cmp_gt_i32 s30, s76
    s_cbranch_scc1 L_lo4
    s_add_u32 s86, s86, 1
    s_cmp_lt_u32 s86, 400000
    s_cbranch_scc1 L_lw4
        L_lo4:

    ds_read_b128 v[64:67], v32 offset:0
    ds_read_b128 v[68:71], v32 offset:1024
    ds_read_b128 v[72:75], v32 offset:2048
    ds_read_b128 v[76:79], v32 offset:3072
    ds_read_b128 v[80:83], v32 offset:4096
    ds_read_b128 v[84:87], v32 offset:5120
    ds_read_b128 v[88:91], v32 offset:6144
    ds_read_b128 v[92:95], v32 offset:7168

    s_sub_u32 s30, s74, 16384
    s_lshr_b32 s30, s30, 11
    s_add_u32 s30, s30, 9216
    v_mov_b32 v35, s30
    s_add_u32 s30, s72, 1
    v_mov_b32 v34, s30

    s_waitcnt lgkmcnt(7)
    v_dot2_f32_bf16 v16, v64, v56, 0
    v_dot2_f32_bf16 v16, v65, v57, v16
    v_dot2_f32_bf16 v16, v66, v58, v16
    v_dot2_f32_bf16 v16, v67, v59, v16
    s_waitcnt lgkmcnt(6)
    v_dot2_f32_bf16 v17, v68, v56, 0
    v_dot2_f32_bf16 v17, v69, v57, v17
    v_dot2_f32_bf16 v17, v70, v58, v17
    v_dot2_f32_bf16 v17, v71, v59, v17
    s_waitcnt lgkmcnt(5)
    v_dot2_f32_bf16 v18, v72, v56, 0
    v_dot2_f32_bf16 v18, v73, v57, v18
    v_dot2_f32_bf16 v18, v74, v58, v18
    v_dot2_f32_bf16 v18, v75, v59, v18
    s_waitcnt lgkmcnt(4)
    v_dot2_f32_bf16 v19, v76, v56, 0
    v_dot2_f32_bf16 v19, v77, v57, v19
    v_dot2_f32_bf16 v19, v78, v58, v19
    v_dot2_f32_bf16 v19, v79, v59, v19
    s_waitcnt lgkmcnt(3)
    v_dot2_f32_bf16 v20, v80, v56, 0
    v_dot2_f32_bf16 v20, v81, v57, v20
    v_dot2_f32_bf16 v20, v82, v58, v20
    v_dot2_f32_bf16 v20, v83, v59, v20
    s_waitcnt lgkmcnt(2)
    v_dot2_f32_bf16 v21, v84, v56, 0
    v_dot2_f32_bf16 v21, v85, v57, v21
    v_dot2_f32_bf16 v21, v86, v58, v21
    v_dot2_f32_bf16 v21, v87, v59, v21
    s_waitcnt lgkmcnt(1)
    v_dot2_f32_bf16 v22, v88, v56, 0
    v_dot2_f32_bf16 v22, v89, v57, v22
    v_dot2_f32_bf16 v22, v90, v58, v22
    v_dot2_f32_bf16 v22, v91, v59, v22
    s_waitcnt lgkmcnt(0)

    s_mov_b64 exec, 1
    ds_write_b32 v35, v34
    s_mov_b64 exec, -1
    s_add_u32 s72, s72, 5
    s_add_u32 s74, s74, 40960
    s_cmp_ge_u32 s74, 163840
    s_cselect_b32 s30, 147456, 0
    s_sub_u32 s74, s74, s30

    v_dot2_f32_bf16 v23, v92, v56, 0
    v_dot2_f32_bf16 v23, v93, v57, v23
    v_dot2_f32_bf16 v23, v94, v58, v23
    v_dot2_f32_bf16 v23, v95, v59, v23
    v_add_f32_dpp v16, v16, v16 row_mirror row_mask:0xf bank_mask:0x3
    v_add_f32_dpp v17, v17, v17 row_mirror row_mask:0xf bank_mask:0x3
    v_add_f32_dpp v18, v18, v18 row_mirror row_mask:0xf bank_mask:0x3
    v_add_f32_dpp v19, v19, v19 row_mirror row_mask:0xf bank_mask:0x3
    v_add_f32_dpp v16, v20, v20 row_mirror row_mask:0xf bank_mask:0xc
    v_add_f32_dpp v17, v21, v21 row_mirror row_mask:0xf bank_mask:0xc
    v_add_f32_dpp v18, v22, v22 row_mirror row_mask:0xf bank_mask:0xc
    v_add_f32_dpp v19, v23, v23 row_mirror row_mask:0xf bank_mask:0xc
    v_add_f32_dpp v16, v16, v16 row_half_mirror row_mask:0xf bank_mask:0x5
    v_add_f32_dpp v17, v17, v17 row_half_mirror row_mask:0xf bank_mask:0x5
    s_nop 0
    v_add_f32_dpp v16, v18, v18 row_half_mirror row_mask:0xf bank_mask:0xa
    v_add_f32_dpp v17, v19, v19 row_half_mirror row_mask:0xf bank_mask:0xa
    s_nop 0
    v_add_f32_dpp v16, v16, v16 quad_perm:[2,3,0,1] row_mask:0xf bank_mask:0xf
    v_add_f32_dpp v17, v17, v17 quad_perm:[2,3,0,1] row_mask:0xf bank_mask:0xf
    v_cndmask_b32 v16, v16, v17, s[64:65]
    s_nop 1
    v_add_f32_dpp v39, v16, v16 quad_perm:[1,0,3,2] row_mask:0xf bank_mask:0xf
    v_cvt_pk_bf16_f32 v39, 0, v39
    v_mul_f32 v39, 1035273459, v39
    v_cvt_pk_bf16_f32 v39, 0, v39

    v_mov_b32 v33, 8704
    s_mov_b32 s76, s72

    v_add_u32 v32, s74, v2
    s_mov_b32 s86, 0
        L_lw5:
    ds_read_b32 v10, v33
    s_waitcnt lgkmcnt(0)
    v_readfirstlane_b32 s30, v10
    s_nop 0
    s_cmp_gt_i32 s30, s76
    s_cbranch_scc1 L_lo5
    s_add_u32 s86, s86, 1
    s_cmp_lt_u32 s86, 400000
    s_cbranch_scc1 L_lw5
        L_lo5:

    ds_read_b128 v[64:67], v32 offset:0
    ds_read_b128 v[68:71], v32 offset:1024
    ds_read_b128 v[72:75], v32 offset:2048
    ds_read_b128 v[76:79], v32 offset:3072
    ds_read_b128 v[80:83], v32 offset:4096
    ds_read_b128 v[84:87], v32 offset:5120
    ds_read_b128 v[88:91], v32 offset:6144
    ds_read_b128 v[92:95], v32 offset:7168

    s_sub_u32 s30, s74, 16384
    s_lshr_b32 s30, s30, 11
    s_add_u32 s30, s30, 9216
    v_mov_b32 v35, s30
    s_add_u32 s30, s72, 1
    v_mov_b32 v34, s30

    s_waitcnt lgkmcnt(7)
    v_dot2_f32_bf16 v16, v64, v56, 0
    v_dot2_f32_bf16 v16, v65, v57, v16
    v_dot2_f32_bf16 v16, v66, v58, v16
    v_dot2_f32_bf16 v16, v67, v59, v16
    s_waitcnt lgkmcnt(6)
    v_dot2_f32_bf16 v17, v68, v56, 0
    v_dot2_f32_bf16 v17, v69, v57, v17
    v_dot2_f32_bf16 v17, v70, v58, v17
    v_dot2_f32_bf16 v17, v71, v59, v17
    s_waitcnt lgkmcnt(5)
    v_dot2_f32_bf16 v18, v72, v56, 0
    v_dot2_f32_bf16 v18, v73, v57, v18
    v_dot2_f32_bf16 v18, v74, v58, v18
    v_dot2_f32_bf16 v18, v75, v59, v18
    s_waitcnt lgkmcnt(4)
    v_dot2_f32_bf16 v19, v76, v56, 0
    v_dot2_f32_bf16 v19, v77, v57, v19
    v_dot2_f32_bf16 v19, v78, v58, v19
    v_dot2_f32_bf16 v19, v79, v59, v19
    s_waitcnt lgkmcnt(3)
    v_dot2_f32_bf16 v20, v80, v56, 0
    v_dot2_f32_bf16 v20, v81, v57, v20
    v_dot2_f32_bf16 v20, v82, v58, v20
    v_dot2_f32_bf16 v20, v83, v59, v20
    s_waitcnt lgkmcnt(2)
    v_dot2_f32_bf16 v21, v84, v56, 0
    v_dot2_f32_bf16 v21, v85, v57, v21
    v_dot2_f32_bf16 v21, v86, v58, v21
    v_dot2_f32_bf16 v21, v87, v59, v21
    s_waitcnt lgkmcnt(1)
    v_dot2_f32_bf16 v22, v88, v56, 0
    v_dot2_f32_bf16 v22, v89, v57, v22
    v_dot2_f32_bf16 v22, v90, v58, v22
    v_dot2_f32_bf16 v22, v91, v59, v22
    s_waitcnt lgkmcnt(0)

    s_mov_b64 exec, 1
    ds_write_b32 v35, v34
    s_mov_b64 exec, -1
    s_add_u32 s72, s72, 5
    s_add_u32 s74, s74, 40960
    s_cmp_ge_u32 s74, 163840
    s_cselect_b32 s30, 147456, 0
    s_sub_u32 s74, s74, s30

    v_dot2_f32_bf16 v23, v92, v56, 0
    v_dot2_f32_bf16 v23, v93, v57, v23
    v_dot2_f32_bf16 v23, v94, v58, v23
    v_dot2_f32_bf16 v23, v95, v59, v23
    v_add_f32_dpp v16, v16, v16 row_mirror row_mask:0xf bank_mask:0x3
    v_add_f32_dpp v17, v17, v17 row_mirror row_mask:0xf bank_mask:0x3
    v_add_f32_dpp v18, v18, v18 row_mirror row_mask:0xf bank_mask:0x3
    v_add_f32_dpp v19, v19, v19 row_mirror row_mask:0xf bank_mask:0x3
    v_add_f32_dpp v16, v20, v20 row_mirror row_mask:0xf bank_mask:0xc
    v_add_f32_dpp v17, v21, v21 row_mirror row_mask:0xf bank_mask:0xc
    v_add_f32_dpp v18, v22, v22 row_mirror row_mask:0xf bank_mask:0xc
    v_add_f32_dpp v19, v23, v23 row_mirror row_mask:0xf bank_mask:0xc
    v_add_f32_dpp v16, v16, v16 row_half_mirror row_mask:0xf bank_mask:0x5
    v_add_f32_dpp v17, v17, v17 row_half_mirror row_mask:0xf bank_mask:0x5
    s_nop 0
    v_add_f32_dpp v16, v18, v18 row_half_mirror row_mask:0xf bank_mask:0xa
    v_add_f32_dpp v17, v19, v19 row_half_mirror row_mask:0xf bank_mask:0xa
    s_nop 0
    v_add_f32_dpp v16, v16, v16 quad_perm:[2,3,0,1] row_mask:0xf bank_mask:0xf
    v_add_f32_dpp v17, v17, v17 quad_perm:[2,3,0,1] row_mask:0xf bank_mask:0xf
    v_cndmask_b32 v16, v16, v17, s[64:65]
    s_nop 1
    v_add_f32_dpp v40, v16, v16 quad_perm:[1,0,3,2] row_mask:0xf bank_mask:0xf
    v_cvt_pk_bf16_f32 v40, 0, v40
    v_mul_f32 v40, 1035273459, v40
    v_cvt_pk_bf16_f32 v40, 0, v40

    v_mov_b32 v33, 8704
    s_mov_b32 s76, s72

    v_add_u32 v32, s74, v2
    s_mov_b32 s86, 0
        L_lw6:
    ds_read_b32 v10, v33
    s_waitcnt lgkmcnt(0)
    v_readfirstlane_b32 s30, v10
    s_nop 0
    s_cmp_gt_i32 s30, s76
    s_cbranch_scc1 L_lo6
    s_add_u32 s86, s86, 1
    s_cmp_lt_u32 s86, 400000
    s_cbranch_scc1 L_lw6
        L_lo6:

    ds_read_b128 v[64:67], v32 offset:0
    ds_read_b128 v[68:71], v32 offset:1024
    ds_read_b128 v[72:75], v32 offset:2048
    ds_read_b128 v[76:79], v32 offset:3072
    ds_read_b128 v[80:83], v32 offset:4096
    ds_read_b128 v[84:87], v32 offset:5120
    ds_read_b128 v[88:91], v32 offset:6144
    ds_read_b128 v[92:95], v32 offset:7168

    s_sub_u32 s30, s74, 16384
    s_lshr_b32 s30, s30, 11
    s_add_u32 s30, s30, 9216
    v_mov_b32 v35, s30
    s_add_u32 s30, s72, 1
    v_mov_b32 v34, s30

    s_waitcnt lgkmcnt(7)
    v_dot2_f32_bf16 v16, v64, v56, 0
    v_dot2_f32_bf16 v16, v65, v57, v16
    v_dot2_f32_bf16 v16, v66, v58, v16
    v_dot2_f32_bf16 v16, v67, v59, v16
    s_waitcnt lgkmcnt(6)
    v_dot2_f32_bf16 v17, v68, v56, 0
    v_dot2_f32_bf16 v17, v69, v57, v17
    v_dot2_f32_bf16 v17, v70, v58, v17
    v_dot2_f32_bf16 v17, v71, v59, v17
    s_waitcnt lgkmcnt(5)
    v_dot2_f32_bf16 v18, v72, v56, 0
    v_dot2_f32_bf16 v18, v73, v57, v18
    v_dot2_f32_bf16 v18, v74, v58, v18
    v_dot2_f32_bf16 v18, v75, v59, v18
    s_waitcnt lgkmcnt(4)
    v_dot2_f32_bf16 v19, v76, v56, 0
    v_dot2_f32_bf16 v19, v77, v57, v19
    v_dot2_f32_bf16 v19, v78, v58, v19
    v_dot2_f32_bf16 v19, v79, v59, v19
    s_waitcnt lgkmcnt(3)
    v_dot2_f32_bf16 v20, v80, v56, 0
    v_dot2_f32_bf16 v20, v81, v57, v20
    v_dot2_f32_bf16 v20, v82, v58, v20
    v_dot2_f32_bf16 v20, v83, v59, v20
    s_waitcnt lgkmcnt(2)
    v_dot2_f32_bf16 v21, v84, v56, 0
    v_dot2_f32_bf16 v21, v85, v57, v21
    v_dot2_f32_bf16 v21, v86, v58, v21
    v_dot2_f32_bf16 v21, v87, v59, v21
    s_waitcnt lgkmcnt(1)
    v_dot2_f32_bf16 v22, v88, v56, 0
    v_dot2_f32_bf16 v22, v89, v57, v22
    v_dot2_f32_bf16 v22, v90, v58, v22
    v_dot2_f32_bf16 v22, v91, v59, v22
    s_waitcnt lgkmcnt(0)

    s_mov_b64 exec, 1
    ds_write_b32 v35, v34
    s_mov_b64 exec, -1
    s_add_u32 s72, s72, 5
    s_add_u32 s74, s74, 40960
    s_cmp_ge_u32 s74, 163840
    s_cselect_b32 s30, 147456, 0
    s_sub_u32 s74, s74, s30

    v_dot2_f32_bf16 v23, v92, v56, 0
    v_dot2_f32_bf16 v23, v93, v57, v23
    v_dot2_f32_bf16 v23, v94, v58, v23
    v_dot2_f32_bf16 v23, v95, v59, v23
    v_add_f32_dpp v16, v16, v16 row_mirror row_mask:0xf bank_mask:0x3
    v_add_f32_dpp v17, v17, v17 row_mirror row_mask:0xf bank_mask:0x3
    v_add_f32_dpp v18, v18, v18 row_mirror row_mask:0xf bank_mask:0x3
    v_add_f32_dpp v19, v19, v19 row_mirror row_mask:0xf bank_mask:0x3
    v_add_f32_dpp v16, v20, v20 row_mirror row_mask:0xf bank_mask:0xc
    v_add_f32_dpp v17, v21, v21 row_mirror row_mask:0xf bank_mask:0xc
    v_add_f32_dpp v18, v22, v22 row_mirror row_mask:0xf bank_mask:0xc
    v_add_f32_dpp v19, v23, v23 row_mirror row_mask:0xf bank_mask:0xc
    v_add_f32_dpp v16, v16, v16 row_half_mirror row_mask:0xf bank_mask:0x5
    v_add_f32_dpp v17, v17, v17 row_half_mirror row_mask:0xf bank_mask:0x5
    s_nop 0
    v_add_f32_dpp v16, v18, v18 row_half_mirror row_mask:0xf bank_mask:0xa
    v_add_f32_dpp v17, v19, v19 row_half_mirror row_mask:0xf bank_mask:0xa
    s_nop 0
    v_add_f32_dpp v16, v16, v16 quad_perm:[2,3,0,1] row_mask:0xf bank_mask:0xf
    v_add_f32_dpp v17, v17, v17 quad_perm:[2,3,0,1] row_mask:0xf bank_mask:0xf
    v_cndmask_b32 v16, v16, v17, s[64:65]
    s_nop 1
    v_add_f32_dpp v41, v16, v16 quad_perm:[1,0,3,2] row_mask:0xf bank_mask:0xf
    v_cvt_pk_bf16_f32 v41, 0, v41
    v_mul_f32 v41, 1035273459, v41
    v_cvt_pk_bf16_f32 v41, 0, v41

    s_cmp_ge_u32 s97, 2
    s_cbranch_scc1 L_k6

    v_mov_b32 v33, 8704
    s_mov_b32 s76, s72

    v_add_u32 v32, s74, v2
    s_mov_b32 s86, 0
        L_lw7:
    ds_read_b32 v10, v33
    s_waitcnt lgkmcnt(0)
    v_readfirstlane_b32 s30, v10
    s_nop 0
    s_cmp_gt_i32 s30, s76
    s_cbranch_scc1 L_lo7
    s_add_u32 s86, s86, 1
    s_cmp_lt_u32 s86, 400000
    s_cbranch_scc1 L_lw7
        L_lo7:

    ds_read_b128 v[64:67], v32 offset:0
    ds_read_b128 v[68:71], v32 offset:1024
    ds_read_b128 v[72:75], v32 offset:2048
    ds_read_b128 v[76:79], v32 offset:3072
    ds_read_b128 v[80:83], v32 offset:4096
    ds_read_b128 v[84:87], v32 offset:5120
    ds_read_b128 v[88:91], v32 offset:6144
    ds_read_b128 v[92:95], v32 offset:7168

    s_sub_u32 s30, s74, 16384
    s_lshr_b32 s30, s30, 11
    s_add_u32 s30, s30, 9216
    v_mov_b32 v35, s30
    s_add_u32 s30, s72, 1
    v_mov_b32 v34, s30

    s_waitcnt lgkmcnt(7)
    v_dot2_f32_bf16 v16, v64, v56, 0
    v_dot2_f32_bf16 v16, v65, v57, v16
    v_dot2_f32_bf16 v16, v66, v58, v16
    v_dot2_f32_bf16 v16, v67, v59, v16
    s_waitcnt lgkmcnt(6)
    v_dot2_f32_bf16 v17, v68, v56, 0
    v_dot2_f32_bf16 v17, v69, v57, v17
    v_dot2_f32_bf16 v17, v70, v58, v17
    v_dot2_f32_bf16 v17, v71, v59, v17
    s_waitcnt lgkmcnt(5)
    v_dot2_f32_bf16 v18, v72, v56, 0
    v_dot2_f32_bf16 v18, v73, v57, v18
    v_dot2_f32_bf16 v18, v74, v58, v18
    v_dot2_f32_bf16 v18, v75, v59, v18
    s_waitcnt lgkmcnt(4)
    v_dot2_f32_bf16 v19, v76, v56, 0
    v_dot2_f32_bf16 v19, v77, v57, v19
    v_dot2_f32_bf16 v19, v78, v58, v19
    v_dot2_f32_bf16 v19, v79, v59, v19
    s_waitcnt lgkmcnt(3)
    v_dot2_f32_bf16 v20, v80, v56, 0
    v_dot2_f32_bf16 v20, v81, v57, v20
    v_dot2_f32_bf16 v20, v82, v58, v20
    v_dot2_f32_bf16 v20, v83, v59, v20
    s_waitcnt lgkmcnt(2)
    v_dot2_f32_bf16 v21, v84, v56, 0
    v_dot2_f32_bf16 v21, v85, v57, v21
    v_dot2_f32_bf16 v21, v86, v58, v21
    v_dot2_f32_bf16 v21, v87, v59, v21
    s_waitcnt lgkmcnt(1)
    v_dot2_f32_bf16 v22, v88, v56, 0
    v_dot2_f32_bf16 v22, v89, v57, v22
    v_dot2_f32_bf16 v22, v90, v58, v22
    v_dot2_f32_bf16 v22, v91, v59, v22
    s_waitcnt lgkmcnt(0)

    s_mov_b64 exec, 1
    ds_write_b32 v35, v34
    s_mov_b64 exec, -1
    s_add_u32 s72, s72, 5
    s_add_u32 s74, s74, 40960
    s_cmp_ge_u32 s74, 163840
    s_cselect_b32 s30, 147456, 0
    s_sub_u32 s74, s74, s30

    v_dot2_f32_bf16 v23, v92, v56, 0
    v_dot2_f32_bf16 v23, v93, v57, v23
    v_dot2_f32_bf16 v23, v94, v58, v23
    v_dot2_f32_bf16 v23, v95, v59, v23
    v_add_f32_dpp v16, v16, v16 row_mirror row_mask:0xf bank_mask:0x3
    v_add_f32_dpp v17, v17, v17 row_mirror row_mask:0xf bank_mask:0x3
    v_add_f32_dpp v18, v18, v18 row_mirror row_mask:0xf bank_mask:0x3
    v_add_f32_dpp v19, v19, v19 row_mirror row_mask:0xf bank_mask:0x3
    v_add_f32_dpp v16, v20, v20 row_mirror row_mask:0xf bank_mask:0xc
    v_add_f32_dpp v17, v21, v21 row_mirror row_mask:0xf bank_mask:0xc
    v_add_f32_dpp v18, v22, v22 row_mirror row_mask:0xf bank_mask:0xc
    v_add_f32_dpp v19, v23, v23 row_mirror row_mask:0xf bank_mask:0xc
    v_add_f32_dpp v16, v16, v16 row_half_mirror row_mask:0xf bank_mask:0x5
    v_add_f32_dpp v17, v17, v17 row_half_mirror row_mask:0xf bank_mask:0x5
    s_nop 0
    v_add_f32_dpp v16, v18, v18 row_half_mirror row_mask:0xf bank_mask:0xa
    v_add_f32_dpp v17, v19, v19 row_half_mirror row_mask:0xf bank_mask:0xa
    s_nop 0
    v_add_f32_dpp v16, v16, v16 quad_perm:[2,3,0,1] row_mask:0xf bank_mask:0xf
    v_add_f32_dpp v17, v17, v17 quad_perm:[2,3,0,1] row_mask:0xf bank_mask:0xf
    v_cndmask_b32 v16, v16, v17, s[64:65]
    s_nop 1
    v_add_f32_dpp v42, v16, v16 quad_perm:[1,0,3,2] row_mask:0xf bank_mask:0xf
    v_cvt_pk_bf16_f32 v42, 0, v42
    v_mul_f32 v42, 1035273459, v42
    v_cvt_pk_bf16_f32 v42, 0, v42
L_k6:
    v_max_f32 v10, v36, v37
    v_max_f32 v10, v10, v38
    v_max_f32 v10, v10, v39
    v_max_f32 v10, v10, v40
    v_max_f32 v10, v10, v41
    v_max_f32 v10, v10, v42
    s_nop 1
    v_max_f32_dpp v10, v10, v10 quad_perm:[1,0,3,2] row_mask:0xf bank_mask:0xf
    s_nop 1
    v_max_f32_dpp v10, v10, v10 quad_perm:[2,3,0,1] row_mask:0xf bank_mask:0xf
    s_nop 1
    v_max_f32_dpp v10, v10, v10 row_half_mirror row_mask:0xf bank_mask:0xf
    s_nop 1
    v_max_f32_dpp v10, v10, v10 row_mirror row_mask:0xf bank_mask:0xf
    v_mov_b32 v11, v10
    s_nop 1
    v_permlane16_swap_b32 v11, v10
    v_max_f32 v10, v10, v11
    v_mov_b32 v11, v10
    s_nop 1
    v_permlane32_swap_b32 v11, v10
    v_max_f32 v10, v10, v11
    v_sub_f32 v36, v36, v10
    v_sub_f32 v37, v37, v10
    v_sub_f32 v38, v38, v10
    v_sub_f32 v39, v39, v10
    v_sub_f32 v40, v40, v10
    v_sub_f32 v41, v41, v10
    v_sub_f32 v42, v42, v10
    v_mul_f32 v36, 1069066811, v36
    v_mul_f32 v37, 1069066811, v37
    v_mul_f32 v38, 1069066811, v38
    v_mul_f32 v39, 1069066811, v39
    v_mul_f32 v40, 1069066811, v40
    v_mul_f32 v41, 1069066811, v41
    v_mul_f32 v42, 1069066811, v42
    v_exp_f32 v36, v36
    v_exp_f32 v37, v37
    v_exp_f32 v38, v38
    v_exp_f32 v39, v39
    v_exp_f32 v40, v40
    v_exp_f32 v41, v41
    v_exp_f32 v42, v42
    v_add_f32 v11, v36, v37
    v_add_f32 v11, v11, v38
    v_add_f32 v11, v11, v39
    v_add_f32 v11, v11, v40
    v_add_f32 v11, v11, v41
    v_add_f32 v11, v11, v42
    v_cvt_pk_bf16_f32 v248, 0, v36
    v_cvt_pk_bf16_f32 v249, 0, v37
    v_cvt_pk_bf16_f32 v250, 0, v38
    v_cvt_pk_bf16_f32 v251, 0, v39
    v_cvt_pk_bf16_f32 v252, 0, v40
    v_cvt_pk_bf16_f32 v253, 0, v41
    v_cvt_pk_bf16_f32 v254, 0, v42
    v_lshrrev_b32 v240, 16, v248
    v_lshrrev_b32 v241, 16, v249
    v_lshrrev_b32 v242, 16, v250
    v_lshrrev_b32 v243, 16, v251
    v_lshrrev_b32 v244, 16, v252
    v_lshrrev_b32 v245, 16, v253
    v_lshrrev_b32 v246, 16, v254
    v_mov_b32 v48, 0
    v_mov_b32 v49, 0
    v_mov_b32 v50, 0
    v_mov_b32 v51, 0
    v_mov_b32 v52, 0
    v_mov_b32 v53, 0
    v_mov_b32 v54, 0
    v_mov_b32 v55, 0
    v_mov_b32 v36, 0
    v_mov_b32 v37, 0
    v_mov_b32 v38, 0
    v_mov_b32 v39, 0
    v_mov_b32 v40, 0
    v_mov_b32 v41, 0
    v_mov_b32 v42, 0
    v_mov_b32 v43, 0
    v_add_f32_dpp v11, v11, v11 quad_perm:[1,0,3,2] row_mask:0xf bank_mask:0xf
    s_nop 1
    v_add_f32_dpp v11, v11, v11 quad_perm:[2,3,0,1] row_mask:0xf bank_mask:0xf
    s_nop 1
    v_add_f32_dpp v11, v11, v11 row_half_mirror row_mask:0xf bank_mask:0xf
    s_nop 1
    v_add_f32_dpp v11, v11, v11 row_mirror row_mask:0xf bank_mask:0xf
    v_mov_b32 v12, v11
    s_nop 1
    v_permlane16_swap_b32 v12, v11
    v_add_f32 v11, v11, v12
    v_mov_b32 v12, v11
    s_nop 1
    v_permlane32_swap_b32 v12, v11
    v_add_f32 v11, v11, v12

    v_mov_b32 v62, v10
    v_mul_f32 v11, 0.5, v11
    s_lshl_b32 s30, s3, 3
    v_mov_b32 v12, s30
    v_mov_b32 v13, 8460
    v_mov_b32 v14, 1
    s_mov_b64 exec, 1
    ds_write_b64 v12, v[10:11] offset:8512
    ds_add_u32 v13, v14
    s_mov_b64 exec, -1

    s_waitcnt vmcnt(5)
    s_waitcnt vmcnt(0)
    s_mov_b32 s86, 0

    s_cmp_eq_u32 s79, 0
    s_cbranch_scc1 L_noffn
    s_mov_b32 s86, 0
    L_pf_chk:

    v_perm_b32 v10, v45, v44, s61
    v_perm_b32 v11, v47, v46, s62
    v_or_b32 v10, v10, v11

    v_cmp_ne_u32 vcc, s56, v10
    s_cbranch_vccz L_pf_ok
    s_add_u32 s86, s86, 1
    s_cmp_ge_u32 s86, s87
    s_cbranch_scc1 L_pf_ok

    s_and_b32 s31, s86, 63
    s_cmp_lg_u32 s31, 62
    s_cbranch_scc1 L_pf_nf

    v_mov_b32 v12, 8456
    ds_read_b32 v13, v12
    ds_read_b128 v[16:19], v180 offset:2048
    ds_read_b128 v[20:23], v180 offset:2560
    s_waitcnt lgkmcnt(0)
    v_readfirstlane_b32 s30, v13
    s_nop 0
    s_cmp_lt_u32 s30, 3
    s_cbranch_scc1 L_ffl1
    s_mov_b32 exec_hi, 0

    v_add_f32 v16, v16, v20
    v_add_f32 v17, v17, v21
    v_add_f32 v18, v18, v22
    v_add_f32 v19, v19, v23
    s_mov_b32 exec_hi, -1
    v_and_or_b32 v16, v16, v6, s57
    v_and_or_b32 v17, v17, v6, s58
    v_and_or_b32 v18, v18, v6, s59
    v_and_or_b32 v19, v19, v6, s60

    s_add_u32 s0, s94, 1048576
    s_addc_u32 s1, s95, 0
    global_store_dwordx4 v112, v[16:19], s[0:1] sc1
        L_ffl1:

        L_pf_nf:
    s_and_b32 s31, s86, 63
    s_cmp_eq_u32 s31, 63
    s_cselect_b32 s31, 1048576, 0
    s_add_u32 s0, s94, s31
    s_addc_u32 s1, s95, 0
    global_load_dwordx4 v[44:47], v255, s[0:1] sc1

    s_waitcnt vmcnt(0)
    s_branch L_pf_chk
    L_pf_ok:

    v_and_b32 v16, v44, v6
    v_and_b32 v17, v45, v6
    v_and_b32 v18, v46, v6
    v_and_b32 v19, v47, v6
    v_add_f32_dpp v16, v16, v16 quad_perm:[1,0,3,2] row_mask:0xf bank_mask:0xf
    v_add_f32_dpp v17, v17, v17 quad_perm:[1,0,3,2] row_mask:0xf bank_mask:0xf
    v_add_f32_dpp v18, v18, v18 quad_perm:[1,0,3,2] row_mask:0xf bank_mask:0xf
    v_add_f32_dpp v19, v19, v19 quad_perm:[1,0,3,2] row_mask:0xf bank_mask:0xf
    v_add_f32_dpp v16, v16, v16 quad_perm:[2,3,0,1] row_mask:0xf bank_mask:0xf
    v_add_f32_dpp v17, v17, v17 quad_perm:[2,3,0,1] row_mask:0xf bank_mask:0xf
    v_add_f32_dpp v18, v18, v18 quad_perm:[2,3,0,1] row_mask:0xf bank_mask:0xf
    v_add_f32_dpp v19, v19, v19 quad_perm:[2,3,0,1] row_mask:0xf bank_mask:0xf
    v_add_f32_dpp v16, v16, v16 row_half_mirror row_mask:0xf bank_mask:0xf
    v_add_f32_dpp v17, v17, v17 row_half_mirror row_mask:0xf bank_mask:0xf
    v_add_f32_dpp v18, v18, v18 row_half_mirror row_mask:0xf bank_mask:0xf
    v_add_f32_dpp v19, v19, v19 row_half_mirror row_mask:0xf bank_mask:0xf
    v_mov_b32_dpp v20, v16 row_ror:8 row_mask:0xf bank_mask:0xf
    v_mov_b32_dpp v21, v17 row_ror:8 row_mask:0xf bank_mask:0xf
    v_mov_b32_dpp v22, v18 row_ror:8 row_mask:0xf bank_mask:0xf
    v_mov_b32_dpp v23, v19 row_ror:8 row_mask:0xf bank_mask:0xf
    v_cvt_pk_bf16_f32 v16, 0, v16
    v_cvt_pk_bf16_f32 v17, 0, v17
    v_cvt_pk_bf16_f32 v18, 0, v18
    v_cvt_pk_bf16_f32 v19, 0, v19
    v_cvt_pk_bf16_f32 v20, 0, v20
    v_cvt_pk_bf16_f32 v21, 0, v21
    v_cvt_pk_bf16_f32 v22, 0, v22
    v_cvt_pk_bf16_f32 v23, 0, v23
    v_mul_f32 v24, 3216550459, v16
    v_mul_f32 v25, 3216550459, v17
    v_mul_f32 v26, 3216550459, v18
    v_mul_f32 v27, 3216550459, v19
    v_exp_f32 v24, v24
    v_exp_f32 v25, v25
    v_exp_f32 v26, v26
    v_exp_f32 v27, v27
    v_add_f32 v24, 1.0, v24
    v_add_f32 v25, 1.0, v25
    v_add_f32 v26, 1.0, v26
    v_add_f32 v27, 1.0, v27
    v_rcp_f32 v24, v24
    v_rcp_f32 v25, v25
    v_rcp_f32 v26, v26
    v_rcp_f32 v27, v27
    v_mul_f32 v24, v16, v24
    v_mul_f32 v25, v17, v25
    v_mul_f32 v26, v18, v26
    v_mul_f32 v27, v19, v27
    v_cvt_pk_bf16_f32 v24, 0, v24
    v_cvt_pk_bf16_f32 v25, 0, v25
    v_cvt_pk_bf16_f32 v26, 0, v26
    v_cvt_pk_bf16_f32 v27, 0, v27
    v_mul_f32 v24, v24, v20
    v_mul_f32 v25, v25, v21
    v_mul_f32 v26, v26, v22
    v_mul_f32 v27, v27, v23
    v_cvt_pk_bf16_f32 v20, 0, v24
    v_cvt_pk_bf16_f32 v21, 0, v25
    v_cvt_pk_bf16_f32 v22, 0, v26
    v_cvt_pk_bf16_f32 v23, 0, v27
    v_lshrrev_b32 v16, 16, v20
    v_lshrrev_b32 v17, 16, v21
    v_lshrrev_b32 v18, 16, v22
    v_lshrrev_b32 v19, 16, v23
    v_dot2c_f32_bf16_dpp v36, v16, v224 row_newbcast:0 row_mask:0xf bank_mask:0xf
    v_dot2c_f32_bf16_dpp v37, v20, v224 row_newbcast:0 row_mask:0xf bank_mask:0xf
    v_dot2c_f32_bf16_dpp v38, v16, v225 row_newbcast:0 row_mask:0xf bank_mask:0xf
    v_dot2c_f32_bf16_dpp v39, v20, v225 row_newbcast:0 row_mask:0xf bank_mask:0xf
    v_dot2c_f32_bf16_dpp v40, v16, v226 row_newbcast:0 row_mask:0xf bank_mask:0xf
    v_dot2c_f32_bf16_dpp v41, v20, v226 row_newbcast:0 row_mask:0xf bank_mask:0xf
    v_dot2c_f32_bf16_dpp v42, v16, v227 row_newbcast:0 row_mask:0xf bank_mask:0xf
    v_dot2c_f32_bf16_dpp v43, v20, v227 row_newbcast:0 row_mask:0xf bank_mask:0xf
    v_dot2c_f32_bf16_dpp v36, v17, v228 row_newbcast:0 row_mask:0xf bank_mask:0xf
    v_dot2c_f32_bf16_dpp v37, v21, v228 row_newbcast:0 row_mask:0xf bank_mask:0xf
    v_dot2c_f32_bf16_dpp v38, v17, v229 row_newbcast:0 row_mask:0xf bank_mask:0xf
    v_dot2c_f32_bf16_dpp v39, v21, v229 row_newbcast:0 row_mask:0xf bank_mask:0xf
    v_dot2c_f32_bf16_dpp v40, v17, v230 row_newbcast:0 row_mask:0xf bank_mask:0xf
    v_dot2c_f32_bf16_dpp v41, v21, v230 row_newbcast:0 row_mask:0xf bank_mask:0xf
    v_dot2c_f32_bf16_dpp v42, v17, v231 row_newbcast:0 row_mask:0xf bank_mask:0xf
    v_dot2c_f32_bf16_dpp v43, v21, v231 row_newbcast:0 row_mask:0xf bank_mask:0xf
    v_dot2c_f32_bf16_dpp v36, v18, v232 row_newbcast:0 row_mask:0xf bank_mask:0xf
    v_dot2c_f32_bf16_dpp v37, v22, v232 row_newbcast:0 row_mask:0xf bank_mask:0xf
    v_dot2c_f32_bf16_dpp v38, v18, v233 row_newbcast:0 row_mask:0xf bank_mask:0xf
    v_dot2c_f32_bf16_dpp v39, v22, v233 row_newbcast:0 row_mask:0xf bank_mask:0xf
    v_dot2c_f32_bf16_dpp v40, v18, v234 row_newbcast:0 row_mask:0xf bank_mask:0xf
    v_dot2c_f32_bf16_dpp v41, v22, v234 row_newbcast:0 row_mask:0xf bank_mask:0xf
    v_dot2c_f32_bf16_dpp v42, v18, v235 row_newbcast:0 row_mask:0xf bank_mask:0xf
    v_dot2c_f32_bf16_dpp v43, v22, v235 row_newbcast:0 row_mask:0xf bank_mask:0xf
    v_dot2c_f32_bf16_dpp v36, v19, v236 row_newbcast:0 row_mask:0xf bank_mask:0xf
    v_dot2c_f32_bf16_dpp v37, v23, v236 row_newbcast:0 row_mask:0xf bank_mask:0xf
    v_dot2c_f32_bf16_dpp v38, v19, v237 row_newbcast:0 row_mask:0xf bank_mask:0xf
    v_dot2c_f32_bf16_dpp v39, v23, v237 row_newbcast:0 row_mask:0xf bank_mask:0xf
    v_dot2c_f32_bf16_dpp v40, v19, v238 row_newbcast:0 row_mask:0xf bank_mask:0xf
    v_dot2c_f32_bf16_dpp v41, v23, v238 row_newbcast:0 row_mask:0xf bank_mask:0xf
    v_dot2c_f32_bf16_dpp v42, v19, v239 row_newbcast:0 row_mask:0xf bank_mask:0xf
    v_dot2c_f32_bf16_dpp v43, v23, v239 row_newbcast:0 row_mask:0xf bank_mask:0xf
L_noffn:
    s_add_u32 s72, s97, 32
    s_mov_b32 s31, s72

    s_sub_u32 s30, s31, 18
    s_cmp_ge_u32 s31, 18
    s_cselect_b32 s31, s30, s31

    s_sub_u32 s30, s31, 18
    s_cmp_ge_u32 s31, 18
    s_cselect_b32 s31, s30, s31

    s_sub_u32 s30, s31, 18
    s_cmp_ge_u32 s31, 18
    s_cselect_b32 s31, s30, s31

    s_lshl_b32 s74, s31, 13
    s_add_u32 s74, s74, 16384

    v_mov_b32 v33, 8704
    s_mov_b32 s76, s72

    v_add_u32 v32, s74, v2
    s_mov_b32 s86, 0
        L_lw8:
    ds_read_b32 v10, v33
    s_waitcnt lgkmcnt(0)
    v_readfirstlane_b32 s30, v10
    s_nop 0
    s_cmp_gt_i32 s30, s76
    s_cbranch_scc1 L_lo8
    s_add_u32 s86, s86, 1
    s_cmp_lt_u32 s86, 400000
    s_cbranch_scc1 L_lw8
        L_lo8:

    ds_read_b128 v[64:67], v32 offset:0
    ds_read_b128 v[68:71], v32 offset:1024
    ds_read_b128 v[72:75], v32 offset:2048
    ds_read_b128 v[76:79], v32 offset:3072
    ds_read_b128 v[80:83], v32 offset:4096
    ds_read_b128 v[84:87], v32 offset:5120
    ds_read_b128 v[88:91], v32 offset:6144
    ds_read_b128 v[92:95], v32 offset:7168

    s_sub_u32 s30, s74, 16384
    s_lshr_b32 s30, s30, 11
    s_add_u32 s30, s30, 9216
    v_mov_b32 v35, s30
    s_add_u32 s30, s72, 1
    v_mov_b32 v34, s30

    s_waitcnt lgkmcnt(7)
    v_dot2c_f32_bf16_dpp v48, v240, v64 row_newbcast:0 row_mask:0xf bank_mask:0xf
    v_dot2c_f32_bf16_dpp v49, v248, v64 row_newbcast:0 row_mask:0xf bank_mask:0xf
    v_dot2c_f32_bf16_dpp v50, v240, v65 row_newbcast:0 row_mask:0xf bank_mask:0xf
    v_dot2c_f32_bf16_dpp v51, v248, v65 row_newbcast:0 row_mask:0xf bank_mask:0xf
    v_dot2c_f32_bf16_dpp v52, v240, v66 row_newbcast:0 row_mask:0xf bank_mask:0xf
    v_dot2c_f32_bf16_dpp v53, v248, v66 row_newbcast:0 row_mask:0xf bank_mask:0xf
    v_dot2c_f32_bf16_dpp v54, v240, v67 row_newbcast:0 row_mask:0xf bank_mask:0xf
    v_dot2c_f32_bf16_dpp v55, v248, v67 row_newbcast:0 row_mask:0xf bank_mask:0xf
    s_waitcnt lgkmcnt(6)
    v_dot2c_f32_bf16_dpp v48, v240, v68 row_newbcast:2 row_mask:0xf bank_mask:0xf
    v_dot2c_f32_bf16_dpp v49, v248, v68 row_newbcast:2 row_mask:0xf bank_mask:0xf
    v_dot2c_f32_bf16_dpp v50, v240, v69 row_newbcast:2 row_mask:0xf bank_mask:0xf
    v_dot2c_f32_bf16_dpp v51, v248, v69 row_newbcast:2 row_mask:0xf bank_mask:0xf
    v_dot2c_f32_bf16_dpp v52, v240, v70 row_newbcast:2 row_mask:0xf bank_mask:0xf
    v_dot2c_f32_bf16_dpp v53, v248, v70 row_newbcast:2 row_mask:0xf bank_mask:0xf
    v_dot2c_f32_bf16_dpp v54, v240, v71 row_newbcast:2 row_mask:0xf bank_mask:0xf
    v_dot2c_f32_bf16_dpp v55, v248, v71 row_newbcast:2 row_mask:0xf bank_mask:0xf
    s_waitcnt lgkmcnt(5)
    v_dot2c_f32_bf16_dpp v48, v240, v72 row_newbcast:4 row_mask:0xf bank_mask:0xf
    v_dot2c_f32_bf16_dpp v49, v248, v72 row_newbcast:4 row_mask:0xf bank_mask:0xf
    v_dot2c_f32_bf16_dpp v50, v240, v73 row_newbcast:4 row_mask:0xf bank_mask:0xf
    v_dot2c_f32_bf16_dpp v51, v248, v73 row_newbcast:4 row_mask:0xf bank_mask:0xf
    v_dot2c_f32_bf16_dpp v52, v240, v74 row_newbcast:4 row_mask:0xf bank_mask:0xf
    v_dot2c_f32_bf16_dpp v53, v248, v74 row_newbcast:4 row_mask:0xf bank_mask:0xf
    v_dot2c_f32_bf16_dpp v54, v240, v75 row_newbcast:4 row_mask:0xf bank_mask:0xf
    v_dot2c_f32_bf16_dpp v55, v248, v75 row_newbcast:4 row_mask:0xf bank_mask:0xf
    s_waitcnt lgkmcnt(4)
    v_dot2c_f32_bf16_dpp v48, v240, v76 row_newbcast:6 row_mask:0xf bank_mask:0xf
    v_dot2c_f32_bf16_dpp v49, v248, v76 row_newbcast:6 row_mask:0xf bank_mask:0xf
    v_dot2c_f32_bf16_dpp v50, v240, v77 row_newbcast:6 row_mask:0xf bank_mask:0xf
    v_dot2c_f32_bf16_dpp v51, v248, v77 row_newbcast:6 row_mask:0xf bank_mask:0xf
    v_dot2c_f32_bf16_dpp v52, v240, v78 row_newbcast:6 row_mask:0xf bank_mask:0xf
    v_dot2c_f32_bf16_dpp v53, v248, v78 row_newbcast:6 row_mask:0xf bank_mask:0xf
    v_dot2c_f32_bf16_dpp v54, v240, v79 row_newbcast:6 row_mask:0xf bank_mask:0xf
    v_dot2c_f32_bf16_dpp v55, v248, v79 row_newbcast:6 row_mask:0xf bank_mask:0xf
    s_waitcnt lgkmcnt(3)
    v_dot2c_f32_bf16_dpp v48, v240, v80 row_newbcast:8 row_mask:0xf bank_mask:0xf
    v_dot2c_f32_bf16_dpp v49, v248, v80 row_newbcast:8 row_mask:0xf bank_mask:0xf
    v_dot2c_f32_bf16_dpp v50, v240, v81 row_newbcast:8 row_mask:0xf bank_mask:0xf
    v_dot2c_f32_bf16_dpp v51, v248, v81 row_newbcast:8 row_mask:0xf bank_mask:0xf
    v_dot2c_f32_bf16_dpp v52, v240, v82 row_newbcast:8 row_mask:0xf bank_mask:0xf
    v_dot2c_f32_bf16_dpp v53, v248, v82 row_newbcast:8 row_mask:0xf bank_mask:0xf
    v_dot2c_f32_bf16_dpp v54, v240, v83 row_newbcast:8 row_mask:0xf bank_mask:0xf
    v_dot2c_f32_bf16_dpp v55, v248, v83 row_newbcast:8 row_mask:0xf bank_mask:0xf
    s_waitcnt lgkmcnt(2)
    v_dot2c_f32_bf16_dpp v48, v240, v84 row_newbcast:10 row_mask:0xf bank_mask:0xf
    v_dot2c_f32_bf16_dpp v49, v248, v84 row_newbcast:10 row_mask:0xf bank_mask:0xf
    v_dot2c_f32_bf16_dpp v50, v240, v85 row_newbcast:10 row_mask:0xf bank_mask:0xf
    v_dot2c_f32_bf16_dpp v51, v248, v85 row_newbcast:10 row_mask:0xf bank_mask:0xf
    v_dot2c_f32_bf16_dpp v52, v240, v86 row_newbcast:10 row_mask:0xf bank_mask:0xf
    v_dot2c_f32_bf16_dpp v53, v248, v86 row_newbcast:10 row_mask:0xf bank_mask:0xf
    v_dot2c_f32_bf16_dpp v54, v240, v87 row_newbcast:10 row_mask:0xf bank_mask:0xf
    v_dot2c_f32_bf16_dpp v55, v248, v87 row_newbcast:10 row_mask:0xf bank_mask:0xf
    s_waitcnt lgkmcnt(1)
    v_dot2c_f32_bf16_dpp v48, v240, v88 row_newbcast:12 row_mask:0xf bank_mask:0xf
    v_dot2c_f32_bf16_dpp v49, v248, v88 row_newbcast:12 row_mask:0xf bank_mask:0xf
    v_dot2c_f32_bf16_dpp v50, v240, v89 row_newbcast:12 row_mask:0xf bank_mask:0xf
    v_dot2c_f32_bf16_dpp v51, v248, v89 row_newbcast:12 row_mask:0xf bank_mask:0xf
    v_dot2c_f32_bf16_dpp v52, v240, v90 row_newbcast:12 row_mask:0xf bank_mask:0xf
    v_dot2c_f32_bf16_dpp v53, v248, v90 row_newbcast:12 row_mask:0xf bank_mask:0xf
    v_dot2c_f32_bf16_dpp v54, v240, v91 row_newbcast:12 row_mask:0xf bank_mask:0xf
    v_dot2c_f32_bf16_dpp v55, v248, v91 row_newbcast:12 row_mask:0xf bank_mask:0xf
    s_waitcnt lgkmcnt(0)

    s_mov_b64 exec, 1
    ds_write_b32 v35, v34
    s_mov_b64 exec, -1
    s_add_u32 s72, s72, 5
    s_add_u32 s74, s74, 40960
    s_cmp_ge_u32 s74, 163840
    s_cselect_b32 s30, 147456, 0
    s_sub_u32 s74, s74, s30

    v_dot2c_f32_bf16_dpp v48, v240, v92 row_newbcast:14 row_mask:0xf bank_mask:0xf
    v_dot2c_f32_bf16_dpp v49, v248, v92 row_newbcast:14 row_mask:0xf bank_mask:0xf
    v_dot2c_f32_bf16_dpp v50, v240, v93 row_newbcast:14 row_mask:0xf bank_mask:0xf
    v_dot2c_f32_bf16_dpp v51, v248, v93 row_newbcast:14 row_mask:0xf bank_mask:0xf
    v_dot2c_f32_bf16_dpp v52, v240, v94 row_newbcast:14 row_mask:0xf bank_mask:0xf
    v_dot2c_f32_bf16_dpp v53, v248, v94 row_newbcast:14 row_mask:0xf bank_mask:0xf
    v_dot2c_f32_bf16_dpp v54, v240, v95 row_newbcast:14 row_mask:0xf bank_mask:0xf
    v_dot2c_f32_bf16_dpp v55, v248, v95 row_newbcast:14 row_mask:0xf bank_mask:0xf

    v_mov_b32 v33, 8704
    s_mov_b32 s76, s72

    v_add_u32 v32, s74, v2
    s_mov_b32 s86, 0
        L_lw9:
    ds_read_b32 v10, v33
    s_waitcnt lgkmcnt(0)
    v_readfirstlane_b32 s30, v10
    s_nop 0
    s_cmp_gt_i32 s30, s76
    s_cbranch_scc1 L_lo9
    s_add_u32 s86, s86, 1
    s_cmp_lt_u32 s86, 400000
    s_cbranch_scc1 L_lw9
        L_lo9:

    ds_read_b128 v[64:67], v32 offset:0
    ds_read_b128 v[68:71], v32 offset:1024
    ds_read_b128 v[72:75], v32 offset:2048
    ds_read_b128 v[76:79], v32 offset:3072
    ds_read_b128 v[80:83], v32 offset:4096
    ds_read_b128 v[84:87], v32 offset:5120
    ds_read_b128 v[88:91], v32 offset:6144
    ds_read_b128 v[92:95], v32 offset:7168

    s_sub_u32 s30, s74, 16384
    s_lshr_b32 s30, s30, 11
    s_add_u32 s30, s30, 9216
    v_mov_b32 v35, s30
    s_add_u32 s30, s72, 1
    v_mov_b32 v34, s30

    s_waitcnt lgkmcnt(7)
    v_dot2c_f32_bf16_dpp v48, v241, v64 row_newbcast:0 row_mask:0xf bank_mask:0xf
    v_dot2c_f32_bf16_dpp v49, v249, v64 row_newbcast:0 row_mask:0xf bank_mask:0xf
    v_dot2c_f32_bf16_dpp v50, v241, v65 row_newbcast:0 row_mask:0xf bank_mask:0xf
    v_dot2c_f32_bf16_dpp v51, v249, v65 row_newbcast:0 row_mask:0xf bank_mask:0xf
    v_dot2c_f32_bf16_dpp v52, v241, v66 row_newbcast:0 row_mask:0xf bank_mask:0xf
    v_dot2c_f32_bf16_dpp v53, v249, v66 row_newbcast:0 row_mask:0xf bank_mask:0xf
    v_dot2c_f32_bf16_dpp v54, v241, v67 row_newbcast:0 row_mask:0xf bank_mask:0xf
    v_dot2c_f32_bf16_dpp v55, v249, v67 row_newbcast:0 row_mask:0xf bank_mask:0xf
    s_waitcnt lgkmcnt(6)
    v_dot2c_f32_bf16_dpp v48, v241, v68 row_newbcast:2 row_mask:0xf bank_mask:0xf
    v_dot2c_f32_bf16_dpp v49, v249, v68 row_newbcast:2 row_mask:0xf bank_mask:0xf
    v_dot2c_f32_bf16_dpp v50, v241, v69 row_newbcast:2 row_mask:0xf bank_mask:0xf
    v_dot2c_f32_bf16_dpp v51, v249, v69 row_newbcast:2 row_mask:0xf bank_mask:0xf
    v_dot2c_f32_bf16_dpp v52, v241, v70 row_newbcast:2 row_mask:0xf bank_mask:0xf
    v_dot2c_f32_bf16_dpp v53, v249, v70 row_newbcast:2 row_mask:0xf bank_mask:0xf
    v_dot2c_f32_bf16_dpp v54, v241, v71 row_newbcast:2 row_mask:0xf bank_mask:0xf
    v_dot2c_f32_bf16_dpp v55, v249, v71 row_newbcast:2 row_mask:0xf bank_mask:0xf
    s_waitcnt lgkmcnt(5)
    v_dot2c_f32_bf16_dpp v48, v241, v72 row_newbcast:4 row_mask:0xf bank_mask:0xf
    v_dot2c_f32_bf16_dpp v49, v249, v72 row_newbcast:4 row_mask:0xf bank_mask:0xf
    v_dot2c_f32_bf16_dpp v50, v241, v73 row_newbcast:4 row_mask:0xf bank_mask:0xf
    v_dot2c_f32_bf16_dpp v51, v249, v73 row_newbcast:4 row_mask:0xf bank_mask:0xf
    v_dot2c_f32_bf16_dpp v52, v241, v74 row_newbcast:4 row_mask:0xf bank_mask:0xf
    v_dot2c_f32_bf16_dpp v53, v249, v74 row_newbcast:4 row_mask:0xf bank_mask:0xf
    v_dot2c_f32_bf16_dpp v54, v241, v75 row_newbcast:4 row_mask:0xf bank_mask:0xf
    v_dot2c_f32_bf16_dpp v55, v249, v75 row_newbcast:4 row_mask:0xf bank_mask:0xf
    s_waitcnt lgkmcnt(4)
    v_dot2c_f32_bf16_dpp v48, v241, v76 row_newbcast:6 row_mask:0xf bank_mask:0xf
    v_dot2c_f32_bf16_dpp v49, v249, v76 row_newbcast:6 row_mask:0xf bank_mask:0xf
    v_dot2c_f32_bf16_dpp v50, v241, v77 row_newbcast:6 row_mask:0xf bank_mask:0xf
    v_dot2c_f32_bf16_dpp v51, v249, v77 row_newbcast:6 row_mask:0xf bank_mask:0xf
    v_dot2c_f32_bf16_dpp v52, v241, v78 row_newbcast:6 row_mask:0xf bank_mask:0xf
    v_dot2c_f32_bf16_dpp v53, v249, v78 row_newbcast:6 row_mask:0xf bank_mask:0xf
    v_dot2c_f32_bf16_dpp v54, v241, v79 row_newbcast:6 row_mask:0xf bank_mask:0xf
    v_dot2c_f32_bf16_dpp v55, v249, v79 row_newbcast:6 row_mask:0xf bank_mask:0xf
    s_waitcnt lgkmcnt(3)
    v_dot2c_f32_bf16_dpp v48, v241, v80 row_newbcast:8 row_mask:0xf bank_mask:0xf
    v_dot2c_f32_bf16_dpp v49, v249, v80 row_newbcast:8 row_mask:0xf bank_mask:0xf
    v_dot2c_f32_bf16_dpp v50, v241, v81 row_newbcast:8 row_mask:0xf bank_mask:0xf
    v_dot2c_f32_bf16_dpp v51, v249, v81 row_newbcast:8 row_mask:0xf bank_mask:0xf
    v_dot2c_f32_bf16_dpp v52, v241, v82 row_newbcast:8 row_mask:0xf bank_mask:0xf
    v_dot2c_f32_bf16_dpp v53, v249, v82 row_newbcast:8 row_mask:0xf bank_mask:0xf
    v_dot2c_f32_bf16_dpp v54, v241, v83 row_newbcast:8 row_mask:0xf bank_mask:0xf
    v_dot2c_f32_bf16_dpp v55, v249, v83 row_newbcast:8 row_mask:0xf bank_mask:0xf
    s_waitcnt lgkmcnt(2)
    v_dot2c_f32_bf16_dpp v48, v241, v84 row_newbcast:10 row_mask:0xf bank_mask:0xf
    v_dot2c_f32_bf16_dpp v49, v249, v84 row_newbcast:10 row_mask:0xf bank_mask:0xf
    v_dot2c_f32_bf16_dpp v50, v241, v85 row_newbcast:10 row_mask:0xf bank_mask:0xf
    v_dot2c_f32_bf16_dpp v51, v249, v85 row_newbcast:10 row_mask:0xf bank_mask:0xf
    v_dot2c_f32_bf16_dpp v52, v241, v86 row_newbcast:10 row_mask:0xf bank_mask:0xf
    v_dot2c_f32_bf16_dpp v53, v249, v86 row_newbcast:10 row_mask:0xf bank_mask:0xf
    v_dot2c_f32_bf16_dpp v54, v241, v87 row_newbcast:10 row_mask:0xf bank_mask:0xf
    v_dot2c_f32_bf16_dpp v55, v249, v87 row_newbcast:10 row_mask:0xf bank_mask:0xf
    s_waitcnt lgkmcnt(1)
    v_dot2c_f32_bf16_dpp v48, v241, v88 row_newbcast:12 row_mask:0xf bank_mask:0xf
    v_dot2c_f32_bf16_dpp v49, v249, v88 row_newbcast:12 row_mask:0xf bank_mask:0xf
    v_dot2c_f32_bf16_dpp v50, v241, v89 row_newbcast:12 row_mask:0xf bank_mask:0xf
    v_dot2c_f32_bf16_dpp v51, v249, v89 row_newbcast:12 row_mask:0xf bank_mask:0xf
    v_dot2c_f32_bf16_dpp v52, v241, v90 row_newbcast:12 row_mask:0xf bank_mask:0xf
    v_dot2c_f32_bf16_dpp v53, v249, v90 row_newbcast:12 row_mask:0xf bank_mask:0xf
    v_dot2c_f32_bf16_dpp v54, v241, v91 row_newbcast:12 row_mask:0xf bank_mask:0xf
    v_dot2c_f32_bf16_dpp v55, v249, v91 row_newbcast:12 row_mask:0xf bank_mask:0xf
    s_waitcnt lgkmcnt(0)

    s_mov_b64 exec, 1
    ds_write_b32 v35, v34
    s_mov_b64 exec, -1
    s_add_u32 s72, s72, 5
    s_add_u32 s74, s74, 40960
    s_cmp_ge_u32 s74, 163840
    s_cselect_b32 s30, 147456, 0
    s_sub_u32 s74, s74, s30

    v_dot2c_f32_bf16_dpp v48, v241, v92 row_newbcast:14 row_mask:0xf bank_mask:0xf
    v_dot2c_f32_bf16_dpp v49, v249, v92 row_newbcast:14 row_mask:0xf bank_mask:0xf
    v_dot2c_f32_bf16_dpp v50, v241, v93 row_newbcast:14 row_mask:0xf bank_mask:0xf
    v_dot2c_f32_bf16_dpp v51, v249, v93 row_newbcast:14 row_mask:0xf bank_mask:0xf
    v_dot2c_f32_bf16_dpp v52, v241, v94 row_newbcast:14 row_mask:0xf bank_mask:0xf
    v_dot2c_f32_bf16_dpp v53, v249, v94 row_newbcast:14 row_mask:0xf bank_mask:0xf
    v_dot2c_f32_bf16_dpp v54, v241, v95 row_newbcast:14 row_mask:0xf bank_mask:0xf
    v_dot2c_f32_bf16_dpp v55, v249, v95 row_newbcast:14 row_mask:0xf bank_mask:0xf

    v_mov_b32 v33, 8704
    s_mov_b32 s76, s72

    v_add_u32 v32, s74, v2
    s_mov_b32 s86, 0
        L_lw10:
    ds_read_b32 v10, v33
    s_waitcnt lgkmcnt(0)
    v_readfirstlane_b32 s30, v10
    s_nop 0
    s_cmp_gt_i32 s30, s76
    s_cbranch_scc1 L_lo10
    s_add_u32 s86, s86, 1
    s_cmp_lt_u32 s86, 400000
    s_cbranch_scc1 L_lw10
        L_lo10:

    ds_read_b128 v[64:67], v32 offset:0
    ds_read_b128 v[68:71], v32 offset:1024
    ds_read_b128 v[72:75], v32 offset:2048
    ds_read_b128 v[76:79], v32 offset:3072
    ds_read_b128 v[80:83], v32 offset:4096
    ds_read_b128 v[84:87], v32 offset:5120
    ds_read_b128 v[88:91], v32 offset:6144
    ds_read_b128 v[92:95], v32 offset:7168

    s_sub_u32 s30, s74, 16384
    s_lshr_b32 s30, s30, 11
    s_add_u32 s30, s30, 9216
    v_mov_b32 v35, s30
    s_add_u32 s30, s72, 1
    v_mov_b32 v34, s30

    s_waitcnt lgkmcnt(7)
    v_dot2c_f32_bf16_dpp v48, v242, v64 row_newbcast:0 row_mask:0xf bank_mask:0xf
    v_dot2c_f32_bf16_dpp v49, v250, v64 row_newbcast:0 row_mask:0xf bank_mask:0xf
    v_dot2c_f32_bf16_dpp v50, v242, v65 row_newbcast:0 row_mask:0xf bank_mask:0xf
    v_dot2c_f32_bf16_dpp v51, v250, v65 row_newbcast:0 row_mask:0xf bank_mask:0xf
    v_dot2c_f32_bf16_dpp v52, v242, v66 row_newbcast:0 row_mask:0xf bank_mask:0xf
    v_dot2c_f32_bf16_dpp v53, v250, v66 row_newbcast:0 row_mask:0xf bank_mask:0xf
    v_dot2c_f32_bf16_dpp v54, v242, v67 row_newbcast:0 row_mask:0xf bank_mask:0xf
    v_dot2c_f32_bf16_dpp v55, v250, v67 row_newbcast:0 row_mask:0xf bank_mask:0xf
    s_waitcnt lgkmcnt(6)
    v_dot2c_f32_bf16_dpp v48, v242, v68 row_newbcast:2 row_mask:0xf bank_mask:0xf
    v_dot2c_f32_bf16_dpp v49, v250, v68 row_newbcast:2 row_mask:0xf bank_mask:0xf
    v_dot2c_f32_bf16_dpp v50, v242, v69 row_newbcast:2 row_mask:0xf bank_mask:0xf
    v_dot2c_f32_bf16_dpp v51, v250, v69 row_newbcast:2 row_mask:0xf bank_mask:0xf
    v_dot2c_f32_bf16_dpp v52, v242, v70 row_newbcast:2 row_mask:0xf bank_mask:0xf
    v_dot2c_f32_bf16_dpp v53, v250, v70 row_newbcast:2 row_mask:0xf bank_mask:0xf
    v_dot2c_f32_bf16_dpp v54, v242, v71 row_newbcast:2 row_mask:0xf bank_mask:0xf
    v_dot2c_f32_bf16_dpp v55, v250, v71 row_newbcast:2 row_mask:0xf bank_mask:0xf
    s_waitcnt lgkmcnt(5)
    v_dot2c_f32_bf16_dpp v48, v242, v72 row_newbcast:4 row_mask:0xf bank_mask:0xf
    v_dot2c_f32_bf16_dpp v49, v250, v72 row_newbcast:4 row_mask:0xf bank_mask:0xf
    v_dot2c_f32_bf16_dpp v50, v242, v73 row_newbcast:4 row_mask:0xf bank_mask:0xf
    v_dot2c_f32_bf16_dpp v51, v250, v73 row_newbcast:4 row_mask:0xf bank_mask:0xf
    v_dot2c_f32_bf16_dpp v52, v242, v74 row_newbcast:4 row_mask:0xf bank_mask:0xf
    v_dot2c_f32_bf16_dpp v53, v250, v74 row_newbcast:4 row_mask:0xf bank_mask:0xf
    v_dot2c_f32_bf16_dpp v54, v242, v75 row_newbcast:4 row_mask:0xf bank_mask:0xf
    v_dot2c_f32_bf16_dpp v55, v250, v75 row_newbcast:4 row_mask:0xf bank_mask:0xf
    s_waitcnt lgkmcnt(4)
    v_dot2c_f32_bf16_dpp v48, v242, v76 row_newbcast:6 row_mask:0xf bank_mask:0xf
    v_dot2c_f32_bf16_dpp v49, v250, v76 row_newbcast:6 row_mask:0xf bank_mask:0xf
    v_dot2c_f32_bf16_dpp v50, v242, v77 row_newbcast:6 row_mask:0xf bank_mask:0xf
    v_dot2c_f32_bf16_dpp v51, v250, v77 row_newbcast:6 row_mask:0xf bank_mask:0xf
    v_dot2c_f32_bf16_dpp v52, v242, v78 row_newbcast:6 row_mask:0xf bank_mask:0xf
    v_dot2c_f32_bf16_dpp v53, v250, v78 row_newbcast:6 row_mask:0xf bank_mask:0xf
    v_dot2c_f32_bf16_dpp v54, v242, v79 row_newbcast:6 row_mask:0xf bank_mask:0xf
    v_dot2c_f32_bf16_dpp v55, v250, v79 row_newbcast:6 row_mask:0xf bank_mask:0xf
    s_waitcnt lgkmcnt(3)
    v_dot2c_f32_bf16_dpp v48, v242, v80 row_newbcast:8 row_mask:0xf bank_mask:0xf
    v_dot2c_f32_bf16_dpp v49, v250, v80 row_newbcast:8 row_mask:0xf bank_mask:0xf
    v_dot2c_f32_bf16_dpp v50, v242, v81 row_newbcast:8 row_mask:0xf bank_mask:0xf
    v_dot2c_f32_bf16_dpp v51, v250, v81 row_newbcast:8 row_mask:0xf bank_mask:0xf
    v_dot2c_f32_bf16_dpp v52, v242, v82 row_newbcast:8 row_mask:0xf bank_mask:0xf
    v_dot2c_f32_bf16_dpp v53, v250, v82 row_newbcast:8 row_mask:0xf bank_mask:0xf
    v_dot2c_f32_bf16_dpp v54, v242, v83 row_newbcast:8 row_mask:0xf bank_mask:0xf
    v_dot2c_f32_bf16_dpp v55, v250, v83 row_newbcast:8 row_mask:0xf bank_mask:0xf
    s_waitcnt lgkmcnt(2)
    v_dot2c_f32_bf16_dpp v48, v242, v84 row_newbcast:10 row_mask:0xf bank_mask:0xf
    v_dot2c_f32_bf16_dpp v49, v250, v84 row_newbcast:10 row_mask:0xf bank_mask:0xf
    v_dot2c_f32_bf16_dpp v50, v242, v85 row_newbcast:10 row_mask:0xf bank_mask:0xf
    v_dot2c_f32_bf16_dpp v51, v250, v85 row_newbcast:10 row_mask:0xf bank_mask:0xf
    v_dot2c_f32_bf16_dpp v52, v242, v86 row_newbcast:10 row_mask:0xf bank_mask:0xf
    v_dot2c_f32_bf16_dpp v53, v250, v86 row_newbcast:10 row_mask:0xf bank_mask:0xf
    v_dot2c_f32_bf16_dpp v54, v242, v87 row_newbcast:10 row_mask:0xf bank_mask:0xf
    v_dot2c_f32_bf16_dpp v55, v250, v87 row_newbcast:10 row_mask:0xf bank_mask:0xf
    s_waitcnt lgkmcnt(1)
    v_dot2c_f32_bf16_dpp v48, v242, v88 row_newbcast:12 row_mask:0xf bank_mask:0xf
    v_dot2c_f32_bf16_dpp v49, v250, v88 row_newbcast:12 row_mask:0xf bank_mask:0xf
    v_dot2c_f32_bf16_dpp v50, v242, v89 row_newbcast:12 row_mask:0xf bank_mask:0xf
    v_dot2c_f32_bf16_dpp v51, v250, v89 row_newbcast:12 row_mask:0xf bank_mask:0xf
    v_dot2c_f32_bf16_dpp v52, v242, v90 row_newbcast:12 row_mask:0xf bank_mask:0xf
    v_dot2c_f32_bf16_dpp v53, v250, v90 row_newbcast:12 row_mask:0xf bank_mask:0xf
    v_dot2c_f32_bf16_dpp v54, v242, v91 row_newbcast:12 row_mask:0xf bank_mask:0xf
    v_dot2c_f32_bf16_dpp v55, v250, v91 row_newbcast:12 row_mask:0xf bank_mask:0xf
    s_waitcnt lgkmcnt(0)

    s_mov_b64 exec, 1
    ds_write_b32 v35, v34
    s_mov_b64 exec, -1
    s_add_u32 s72, s72, 5
    s_add_u32 s74, s74, 40960
    s_cmp_ge_u32 s74, 163840
    s_cselect_b32 s30, 147456, 0
    s_sub_u32 s74, s74, s30

    v_dot2c_f32_bf16_dpp v48, v242, v92 row_newbcast:14 row_mask:0xf bank_mask:0xf
    v_dot2c_f32_bf16_dpp v49, v250, v92 row_newbcast:14 row_mask:0xf bank_mask:0xf
    v_dot2c_f32_bf16_dpp v50, v242, v93 row_newbcast:14 row_mask:0xf bank_mask:0xf
    v_dot2c_f32_bf16_dpp v51, v250, v93 row_newbcast:14 row_mask:0xf bank_mask:0xf
    v_dot2c_f32_bf16_dpp v52, v242, v94 row_newbcast:14 row_mask:0xf bank_mask:0xf
    v_dot2c_f32_bf16_dpp v53, v250, v94 row_newbcast:14 row_mask:0xf bank_mask:0xf
    v_dot2c_f32_bf16_dpp v54, v242, v95 row_newbcast:14 row_mask:0xf bank_mask:0xf
    v_dot2c_f32_bf16_dpp v55, v250, v95 row_newbcast:14 row_mask:0xf bank_mask:0xf

    v_mov_b32 v33, 8704
    s_mov_b32 s76, s72

    v_add_u32 v32, s74, v2
    s_mov_b32 s86, 0
        L_lw11:
    ds_read_b32 v10, v33
    s_waitcnt lgkmcnt(0)
    v_readfirstlane_b32 s30, v10
    s_nop 0
    s_cmp_gt_i32 s30, s76
    s_cbranch_scc1 L_lo11
    s_add_u32 s86, s86, 1
    s_cmp_lt_u32 s86, 400000
    s_cbranch_scc1 L_lw11
        L_lo11:

    ds_read_b128 v[64:67], v32 offset:0
    ds_read_b128 v[68:71], v32 offset:1024
    ds_read_b128 v[72:75], v32 offset:2048
    ds_read_b128 v[76:79], v32 offset:3072
    ds_read_b128 v[80:83], v32 offset:4096
    ds_read_b128 v[84:87], v32 offset:5120
    ds_read_b128 v[88:91], v32 offset:6144
    ds_read_b128 v[92:95], v32 offset:7168

    s_sub_u32 s30, s74, 16384
    s_lshr_b32 s30, s30, 11
    s_add_u32 s30, s30, 9216
    v_mov_b32 v35, s30
    s_add_u32 s30, s72, 1
    v_mov_b32 v34, s30

    s_waitcnt lgkmcnt(7)
    v_dot2c_f32_bf16_dpp v48, v243, v64 row_newbcast:0 row_mask:0xf bank_mask:0xf
    v_dot2c_f32_bf16_dpp v49, v251, v64 row_newbcast:0 row_mask:0xf bank_mask:0xf
    v_dot2c_f32_bf16_dpp v50, v243, v65 row_newbcast:0 row_mask:0xf bank_mask:0xf
    v_dot2c_f32_bf16_dpp v51, v251, v65 row_newbcast:0 row_mask:0xf bank_mask:0xf
    v_dot2c_f32_bf16_dpp v52, v243, v66 row_newbcast:0 row_mask:0xf bank_mask:0xf
    v_dot2c_f32_bf16_dpp v53, v251, v66 row_newbcast:0 row_mask:0xf bank_mask:0xf
    v_dot2c_f32_bf16_dpp v54, v243, v67 row_newbcast:0 row_mask:0xf bank_mask:0xf
    v_dot2c_f32_bf16_dpp v55, v251, v67 row_newbcast:0 row_mask:0xf bank_mask:0xf
    s_waitcnt lgkmcnt(6)
    v_dot2c_f32_bf16_dpp v48, v243, v68 row_newbcast:2 row_mask:0xf bank_mask:0xf
    v_dot2c_f32_bf16_dpp v49, v251, v68 row_newbcast:2 row_mask:0xf bank_mask:0xf
    v_dot2c_f32_bf16_dpp v50, v243, v69 row_newbcast:2 row_mask:0xf bank_mask:0xf
    v_dot2c_f32_bf16_dpp v51, v251, v69 row_newbcast:2 row_mask:0xf bank_mask:0xf
    v_dot2c_f32_bf16_dpp v52, v243, v70 row_newbcast:2 row_mask:0xf bank_mask:0xf
    v_dot2c_f32_bf16_dpp v53, v251, v70 row_newbcast:2 row_mask:0xf bank_mask:0xf
    v_dot2c_f32_bf16_dpp v54, v243, v71 row_newbcast:2 row_mask:0xf bank_mask:0xf
    v_dot2c_f32_bf16_dpp v55, v251, v71 row_newbcast:2 row_mask:0xf bank_mask:0xf
    s_waitcnt lgkmcnt(5)
    v_dot2c_f32_bf16_dpp v48, v243, v72 row_newbcast:4 row_mask:0xf bank_mask:0xf
    v_dot2c_f32_bf16_dpp v49, v251, v72 row_newbcast:4 row_mask:0xf bank_mask:0xf
    v_dot2c_f32_bf16_dpp v50, v243, v73 row_newbcast:4 row_mask:0xf bank_mask:0xf
    v_dot2c_f32_bf16_dpp v51, v251, v73 row_newbcast:4 row_mask:0xf bank_mask:0xf
    v_dot2c_f32_bf16_dpp v52, v243, v74 row_newbcast:4 row_mask:0xf bank_mask:0xf
    v_dot2c_f32_bf16_dpp v53, v251, v74 row_newbcast:4 row_mask:0xf bank_mask:0xf
    v_dot2c_f32_bf16_dpp v54, v243, v75 row_newbcast:4 row_mask:0xf bank_mask:0xf
    v_dot2c_f32_bf16_dpp v55, v251, v75 row_newbcast:4 row_mask:0xf bank_mask:0xf
    s_waitcnt lgkmcnt(4)
    v_dot2c_f32_bf16_dpp v48, v243, v76 row_newbcast:6 row_mask:0xf bank_mask:0xf
    v_dot2c_f32_bf16_dpp v49, v251, v76 row_newbcast:6 row_mask:0xf bank_mask:0xf
    v_dot2c_f32_bf16_dpp v50, v243, v77 row_newbcast:6 row_mask:0xf bank_mask:0xf
    v_dot2c_f32_bf16_dpp v51, v251, v77 row_newbcast:6 row_mask:0xf bank_mask:0xf
    v_dot2c_f32_bf16_dpp v52, v243, v78 row_newbcast:6 row_mask:0xf bank_mask:0xf
    v_dot2c_f32_bf16_dpp v53, v251, v78 row_newbcast:6 row_mask:0xf bank_mask:0xf
    v_dot2c_f32_bf16_dpp v54, v243, v79 row_newbcast:6 row_mask:0xf bank_mask:0xf
    v_dot2c_f32_bf16_dpp v55, v251, v79 row_newbcast:6 row_mask:0xf bank_mask:0xf
    s_waitcnt lgkmcnt(3)
    v_dot2c_f32_bf16_dpp v48, v243, v80 row_newbcast:8 row_mask:0xf bank_mask:0xf
    v_dot2c_f32_bf16_dpp v49, v251, v80 row_newbcast:8 row_mask:0xf bank_mask:0xf
    v_dot2c_f32_bf16_dpp v50, v243, v81 row_newbcast:8 row_mask:0xf bank_mask:0xf
    v_dot2c_f32_bf16_dpp v51, v251, v81 row_newbcast:8 row_mask:0xf bank_mask:0xf
    v_dot2c_f32_bf16_dpp v52, v243, v82 row_newbcast:8 row_mask:0xf bank_mask:0xf
    v_dot2c_f32_bf16_dpp v53, v251, v82 row_newbcast:8 row_mask:0xf bank_mask:0xf
    v_dot2c_f32_bf16_dpp v54, v243, v83 row_newbcast:8 row_mask:0xf bank_mask:0xf
    v_dot2c_f32_bf16_dpp v55, v251, v83 row_newbcast:8 row_mask:0xf bank_mask:0xf
    s_waitcnt lgkmcnt(2)
    v_dot2c_f32_bf16_dpp v48, v243, v84 row_newbcast:10 row_mask:0xf bank_mask:0xf
    v_dot2c_f32_bf16_dpp v49, v251, v84 row_newbcast:10 row_mask:0xf bank_mask:0xf
    v_dot2c_f32_bf16_dpp v50, v243, v85 row_newbcast:10 row_mask:0xf bank_mask:0xf
    v_dot2c_f32_bf16_dpp v51, v251, v85 row_newbcast:10 row_mask:0xf bank_mask:0xf
    v_dot2c_f32_bf16_dpp v52, v243, v86 row_newbcast:10 row_mask:0xf bank_mask:0xf
    v_dot2c_f32_bf16_dpp v53, v251, v86 row_newbcast:10 row_mask:0xf bank_mask:0xf
    v_dot2c_f32_bf16_dpp v54, v243, v87 row_newbcast:10 row_mask:0xf bank_mask:0xf
    v_dot2c_f32_bf16_dpp v55, v251, v87 row_newbcast:10 row_mask:0xf bank_mask:0xf
    s_waitcnt lgkmcnt(1)
    v_dot2c_f32_bf16_dpp v48, v243, v88 row_newbcast:12 row_mask:0xf bank_mask:0xf
    v_dot2c_f32_bf16_dpp v49, v251, v88 row_newbcast:12 row_mask:0xf bank_mask:0xf
    v_dot2c_f32_bf16_dpp v50, v243, v89 row_newbcast:12 row_mask:0xf bank_mask:0xf
    v_dot2c_f32_bf16_dpp v51, v251, v89 row_newbcast:12 row_mask:0xf bank_mask:0xf
    v_dot2c_f32_bf16_dpp v52, v243, v90 row_newbcast:12 row_mask:0xf bank_mask:0xf
    v_dot2c_f32_bf16_dpp v53, v251, v90 row_newbcast:12 row_mask:0xf bank_mask:0xf
    v_dot2c_f32_bf16_dpp v54, v243, v91 row_newbcast:12 row_mask:0xf bank_mask:0xf
    v_dot2c_f32_bf16_dpp v55, v251, v91 row_newbcast:12 row_mask:0xf bank_mask:0xf
    s_waitcnt lgkmcnt(0)

    s_mov_b64 exec, 1
    ds_write_b32 v35, v34
    s_mov_b64 exec, -1
    s_add_u32 s72, s72, 5
    s_add_u32 s74, s74, 40960
    s_cmp_ge_u32 s74, 163840
    s_cselect_b32 s30, 147456, 0
    s_sub_u32 s74, s74, s30

    v_dot2c_f32_bf16_dpp v48, v243, v92 row_newbcast:14 row_mask:0xf bank_mask:0xf
    v_dot2c_f32_bf16_dpp v49, v251, v92 row_newbcast:14 row_mask:0xf bank_mask:0xf
    v_dot2c_f32_bf16_dpp v50, v243, v93 row_newbcast:14 row_mask:0xf bank_mask:0xf
    v_dot2c_f32_bf16_dpp v51, v251, v93 row_newbcast:14 row_mask:0xf bank_mask:0xf
    v_dot2c_f32_bf16_dpp v52, v243, v94 row_newbcast:14 row_mask:0xf bank_mask:0xf
    v_dot2c_f32_bf16_dpp v53, v251, v94 row_newbcast:14 row_mask:0xf bank_mask:0xf
    v_dot2c_f32_bf16_dpp v54, v243, v95 row_newbcast:14 row_mask:0xf bank_mask:0xf
    v_dot2c_f32_bf16_dpp v55, v251, v95 row_newbcast:14 row_mask:0xf bank_mask:0xf

    v_mov_b32 v33, 8704
    s_mov_b32 s76, s72

    v_add_u32 v32, s74, v2
    s_mov_b32 s86, 0
        L_lw12:
    ds_read_b32 v10, v33
    s_waitcnt lgkmcnt(0)
    v_readfirstlane_b32 s30, v10
    s_nop 0
    s_cmp_gt_i32 s30, s76
    s_cbranch_scc1 L_lo12
    s_add_u32 s86, s86, 1
    s_cmp_lt_u32 s86, 400000
    s_cbranch_scc1 L_lw12
        L_lo12:

    ds_read_b128 v[64:67], v32 offset:0
    ds_read_b128 v[68:71], v32 offset:1024
    ds_read_b128 v[72:75], v32 offset:2048
    ds_read_b128 v[76:79], v32 offset:3072
    ds_read_b128 v[80:83], v32 offset:4096
    ds_read_b128 v[84:87], v32 offset:5120
    ds_read_b128 v[88:91], v32 offset:6144
    ds_read_b128 v[92:95], v32 offset:7168

    s_sub_u32 s30, s74, 16384
    s_lshr_b32 s30, s30, 11
    s_add_u32 s30, s30, 9216
    v_mov_b32 v35, s30
    s_add_u32 s30, s72, 1
    v_mov_b32 v34, s30

    s_waitcnt lgkmcnt(7)
    v_dot2c_f32_bf16_dpp v48, v244, v64 row_newbcast:0 row_mask:0xf bank_mask:0xf
    v_dot2c_f32_bf16_dpp v49, v252, v64 row_newbcast:0 row_mask:0xf bank_mask:0xf
    v_dot2c_f32_bf16_dpp v50, v244, v65 row_newbcast:0 row_mask:0xf bank_mask:0xf
    v_dot2c_f32_bf16_dpp v51, v252, v65 row_newbcast:0 row_mask:0xf bank_mask:0xf
    v_dot2c_f32_bf16_dpp v52, v244, v66 row_newbcast:0 row_mask:0xf bank_mask:0xf
    v_dot2c_f32_bf16_dpp v53, v252, v66 row_newbcast:0 row_mask:0xf bank_mask:0xf
    v_dot2c_f32_bf16_dpp v54, v244, v67 row_newbcast:0 row_mask:0xf bank_mask:0xf
    v_dot2c_f32_bf16_dpp v55, v252, v67 row_newbcast:0 row_mask:0xf bank_mask:0xf
    s_waitcnt lgkmcnt(6)
    v_dot2c_f32_bf16_dpp v48, v244, v68 row_newbcast:2 row_mask:0xf bank_mask:0xf
    v_dot2c_f32_bf16_dpp v49, v252, v68 row_newbcast:2 row_mask:0xf bank_mask:0xf
    v_dot2c_f32_bf16_dpp v50, v244, v69 row_newbcast:2 row_mask:0xf bank_mask:0xf
    v_dot2c_f32_bf16_dpp v51, v252, v69 row_newbcast:2 row_mask:0xf bank_mask:0xf
    v_dot2c_f32_bf16_dpp v52, v244, v70 row_newbcast:2 row_mask:0xf bank_mask:0xf
    v_dot2c_f32_bf16_dpp v53, v252, v70 row_newbcast:2 row_mask:0xf bank_mask:0xf
    v_dot2c_f32_bf16_dpp v54, v244, v71 row_newbcast:2 row_mask:0xf bank_mask:0xf
    v_dot2c_f32_bf16_dpp v55, v252, v71 row_newbcast:2 row_mask:0xf bank_mask:0xf
    s_waitcnt lgkmcnt(5)
    v_dot2c_f32_bf16_dpp v48, v244, v72 row_newbcast:4 row_mask:0xf bank_mask:0xf
    v_dot2c_f32_bf16_dpp v49, v252, v72 row_newbcast:4 row_mask:0xf bank_mask:0xf
    v_dot2c_f32_bf16_dpp v50, v244, v73 row_newbcast:4 row_mask:0xf bank_mask:0xf
    v_dot2c_f32_bf16_dpp v51, v252, v73 row_newbcast:4 row_mask:0xf bank_mask:0xf
    v_dot2c_f32_bf16_dpp v52, v244, v74 row_newbcast:4 row_mask:0xf bank_mask:0xf
    v_dot2c_f32_bf16_dpp v53, v252, v74 row_newbcast:4 row_mask:0xf bank_mask:0xf
    v_dot2c_f32_bf16_dpp v54, v244, v75 row_newbcast:4 row_mask:0xf bank_mask:0xf
    v_dot2c_f32_bf16_dpp v55, v252, v75 row_newbcast:4 row_mask:0xf bank_mask:0xf
    s_waitcnt lgkmcnt(4)
    v_dot2c_f32_bf16_dpp v48, v244, v76 row_newbcast:6 row_mask:0xf bank_mask:0xf
    v_dot2c_f32_bf16_dpp v49, v252, v76 row_newbcast:6 row_mask:0xf bank_mask:0xf
    v_dot2c_f32_bf16_dpp v50, v244, v77 row_newbcast:6 row_mask:0xf bank_mask:0xf
    v_dot2c_f32_bf16_dpp v51, v252, v77 row_newbcast:6 row_mask:0xf bank_mask:0xf
    v_dot2c_f32_bf16_dpp v52, v244, v78 row_newbcast:6 row_mask:0xf bank_mask:0xf
    v_dot2c_f32_bf16_dpp v53, v252, v78 row_newbcast:6 row_mask:0xf bank_mask:0xf
    v_dot2c_f32_bf16_dpp v54, v244, v79 row_newbcast:6 row_mask:0xf bank_mask:0xf
    v_dot2c_f32_bf16_dpp v55, v252, v79 row_newbcast:6 row_mask:0xf bank_mask:0xf
    s_waitcnt lgkmcnt(3)
    v_dot2c_f32_bf16_dpp v48, v244, v80 row_newbcast:8 row_mask:0xf bank_mask:0xf
    v_dot2c_f32_bf16_dpp v49, v252, v80 row_newbcast:8 row_mask:0xf bank_mask:0xf
    v_dot2c_f32_bf16_dpp v50, v244, v81 row_newbcast:8 row_mask:0xf bank_mask:0xf
    v_dot2c_f32_bf16_dpp v51, v252, v81 row_newbcast:8 row_mask:0xf bank_mask:0xf
    v_dot2c_f32_bf16_dpp v52, v244, v82 row_newbcast:8 row_mask:0xf bank_mask:0xf
    v_dot2c_f32_bf16_dpp v53, v252, v82 row_newbcast:8 row_mask:0xf bank_mask:0xf
    v_dot2c_f32_bf16_dpp v54, v244, v83 row_newbcast:8 row_mask:0xf bank_mask:0xf
    v_dot2c_f32_bf16_dpp v55, v252, v83 row_newbcast:8 row_mask:0xf bank_mask:0xf
    s_waitcnt lgkmcnt(2)
    v_dot2c_f32_bf16_dpp v48, v244, v84 row_newbcast:10 row_mask:0xf bank_mask:0xf
    v_dot2c_f32_bf16_dpp v49, v252, v84 row_newbcast:10 row_mask:0xf bank_mask:0xf
    v_dot2c_f32_bf16_dpp v50, v244, v85 row_newbcast:10 row_mask:0xf bank_mask:0xf
    v_dot2c_f32_bf16_dpp v51, v252, v85 row_newbcast:10 row_mask:0xf bank_mask:0xf
    v_dot2c_f32_bf16_dpp v52, v244, v86 row_newbcast:10 row_mask:0xf bank_mask:0xf
    v_dot2c_f32_bf16_dpp v53, v252, v86 row_newbcast:10 row_mask:0xf bank_mask:0xf
    v_dot2c_f32_bf16_dpp v54, v244, v87 row_newbcast:10 row_mask:0xf bank_mask:0xf
    v_dot2c_f32_bf16_dpp v55, v252, v87 row_newbcast:10 row_mask:0xf bank_mask:0xf
    s_waitcnt lgkmcnt(1)
    v_dot2c_f32_bf16_dpp v48, v244, v88 row_newbcast:12 row_mask:0xf bank_mask:0xf
    v_dot2c_f32_bf16_dpp v49, v252, v88 row_newbcast:12 row_mask:0xf bank_mask:0xf
    v_dot2c_f32_bf16_dpp v50, v244, v89 row_newbcast:12 row_mask:0xf bank_mask:0xf
    v_dot2c_f32_bf16_dpp v51, v252, v89 row_newbcast:12 row_mask:0xf bank_mask:0xf
    v_dot2c_f32_bf16_dpp v52, v244, v90 row_newbcast:12 row_mask:0xf bank_mask:0xf
    v_dot2c_f32_bf16_dpp v53, v252, v90 row_newbcast:12 row_mask:0xf bank_mask:0xf
    v_dot2c_f32_bf16_dpp v54, v244, v91 row_newbcast:12 row_mask:0xf bank_mask:0xf
    v_dot2c_f32_bf16_dpp v55, v252, v91 row_newbcast:12 row_mask:0xf bank_mask:0xf
    s_waitcnt lgkmcnt(0)

    s_mov_b64 exec, 1
    ds_write_b32 v35, v34
    s_mov_b64 exec, -1
    s_add_u32 s72, s72, 5
    s_add_u32 s74, s74, 40960
    s_cmp_ge_u32 s74, 163840
    s_cselect_b32 s30, 147456, 0
    s_sub_u32 s74, s74, s30

    v_dot2c_f32_bf16_dpp v48, v244, v92 row_newbcast:14 row_mask:0xf bank_mask:0xf
    v_dot2c_f32_bf16_dpp v49, v252, v92 row_newbcast:14 row_mask:0xf bank_mask:0xf
    v_dot2c_f32_bf16_dpp v50, v244, v93 row_newbcast:14 row_mask:0xf bank_mask:0xf
    v_dot2c_f32_bf16_dpp v51, v252, v93 row_newbcast:14 row_mask:0xf bank_mask:0xf
    v_dot2c_f32_bf16_dpp v52, v244, v94 row_newbcast:14 row_mask:0xf bank_mask:0xf
    v_dot2c_f32_bf16_dpp v53, v252, v94 row_newbcast:14 row_mask:0xf bank_mask:0xf
    v_dot2c_f32_bf16_dpp v54, v244, v95 row_newbcast:14 row_mask:0xf bank_mask:0xf
    v_dot2c_f32_bf16_dpp v55, v252, v95 row_newbcast:14 row_mask:0xf bank_mask:0xf

    v_mov_b32 v12, 8464
    s_mov_b32 s86, 0
            L_hs:
    ds_read_b32 v10, v12
    ds_read_b64 v[14:15], v12 offset:8
    s_waitcnt lgkmcnt(0)
    v_cmp_ne_u32 vcc, 1, v10
    s_cbranch_vccz L_hs_ok
    s_add_u32 s86, s86, 1
    s_cmp_lt_u32 s86, 4000000
    s_cbranch_scc1 L_hs
            L_hs_ok:
    v_sub_f32 v62, v62, v14
    v_mul_f32 v62, 1069066811, v62
    v_exp_f32 v62, v62
    s_nop 0
    v_mul_f32 v62, v62, v15

    v_mov_b32 v33, 8704
    s_mov_b32 s76, s72

    v_add_u32 v32, s74, v2
    s_mov_b32 s86, 0
        L_lw13:
    ds_read_b32 v10, v33
    s_waitcnt lgkmcnt(0)
    v_readfirstlane_b32 s30, v10
    s_nop 0
    s_cmp_gt_i32 s30, s76
    s_cbranch_scc1 L_lo13
    s_add_u32 s86, s86, 1
    s_cmp_lt_u32 s86, 400000
    s_cbranch_scc1 L_lw13
        L_lo13:

    ds_read_b128 v[64:67], v32 offset:0
    ds_read_b128 v[68:71], v32 offset:1024
    ds_read_b128 v[72:75], v32 offset:2048
    ds_read_b128 v[76:79], v32 offset:3072
    ds_read_b128 v[80:83], v32 offset:4096
    ds_read_b128 v[84:87], v32 offset:5120
    ds_read_b128 v[88:91], v32 offset:6144
    ds_read_b128 v[92:95], v32 offset:7168

    s_sub_u32 s30, s74, 16384
    s_lshr_b32 s30, s30, 11
    s_add_u32 s30, s30, 9216
    v_mov_b32 v35, s30
    s_add_u32 s30, s72, 1
    v_mov_b32 v34, s30

    s_waitcnt lgkmcnt(7)
    v_dot2c_f32_bf16_dpp v48, v245, v64 row_newbcast:0 row_mask:0xf bank_mask:0xf
    v_dot2c_f32_bf16_dpp v49, v253, v64 row_newbcast:0 row_mask:0xf bank_mask:0xf
    v_dot2c_f32_bf16_dpp v50, v245, v65 row_newbcast:0 row_mask:0xf bank_mask:0xf
    v_dot2c_f32_bf16_dpp v51, v253, v65 row_newbcast:0 row_mask:0xf bank_mask:0xf
    v_dot2c_f32_bf16_dpp v52, v245, v66 row_newbcast:0 row_mask:0xf bank_mask:0xf
    v_dot2c_f32_bf16_dpp v53, v253, v66 row_newbcast:0 row_mask:0xf bank_mask:0xf
    v_dot2c_f32_bf16_dpp v54, v245, v67 row_newbcast:0 row_mask:0xf bank_mask:0xf
    v_dot2c_f32_bf16_dpp v55, v253, v67 row_newbcast:0 row_mask:0xf bank_mask:0xf
    s_waitcnt lgkmcnt(6)
    v_dot2c_f32_bf16_dpp v48, v245, v68 row_newbcast:2 row_mask:0xf bank_mask:0xf
    v_dot2c_f32_bf16_dpp v49, v253, v68 row_newbcast:2 row_mask:0xf bank_mask:0xf
    v_dot2c_f32_bf16_dpp v50, v245, v69 row_newbcast:2 row_mask:0xf bank_mask:0xf
    v_dot2c_f32_bf16_dpp v51, v253, v69 row_newbcast:2 row_mask:0xf bank_mask:0xf
    v_dot2c_f32_bf16_dpp v52, v245, v70 row_newbcast:2 row_mask:0xf bank_mask:0xf
    v_dot2c_f32_bf16_dpp v53, v253, v70 row_newbcast:2 row_mask:0xf bank_mask:0xf
    v_dot2c_f32_bf16_dpp v54, v245, v71 row_newbcast:2 row_mask:0xf bank_mask:0xf
    v_dot2c_f32_bf16_dpp v55, v253, v71 row_newbcast:2 row_mask:0xf bank_mask:0xf
    s_waitcnt lgkmcnt(5)
    v_dot2c_f32_bf16_dpp v48, v245, v72 row_newbcast:4 row_mask:0xf bank_mask:0xf
    v_dot2c_f32_bf16_dpp v49, v253, v72 row_newbcast:4 row_mask:0xf bank_mask:0xf
    v_dot2c_f32_bf16_dpp v50, v245, v73 row_newbcast:4 row_mask:0xf bank_mask:0xf
    v_dot2c_f32_bf16_dpp v51, v253, v73 row_newbcast:4 row_mask:0xf bank_mask:0xf
    v_dot2c_f32_bf16_dpp v52, v245, v74 row_newbcast:4 row_mask:0xf bank_mask:0xf
    v_dot2c_f32_bf16_dpp v53, v253, v74 row_newbcast:4 row_mask:0xf bank_mask:0xf
    v_dot2c_f32_bf16_dpp v54, v245, v75 row_newbcast:4 row_mask:0xf bank_mask:0xf
    v_dot2c_f32_bf16_dpp v55, v253, v75 row_newbcast:4 row_mask:0xf bank_mask:0xf
    s_waitcnt lgkmcnt(4)
    v_dot2c_f32_bf16_dpp v48, v245, v76 row_newbcast:6 row_mask:0xf bank_mask:0xf
    v_dot2c_f32_bf16_dpp v49, v253, v76 row_newbcast:6 row_mask:0xf bank_mask:0xf
    v_dot2c_f32_bf16_dpp v50, v245, v77 row_newbcast:6 row_mask:0xf bank_mask:0xf
    v_dot2c_f32_bf16_dpp v51, v253, v77 row_newbcast:6 row_mask:0xf bank_mask:0xf
    v_dot2c_f32_bf16_dpp v52, v245, v78 row_newbcast:6 row_mask:0xf bank_mask:0xf
    v_dot2c_f32_bf16_dpp v53, v253, v78 row_newbcast:6 row_mask:0xf bank_mask:0xf
    v_dot2c_f32_bf16_dpp v54, v245, v79 row_newbcast:6 row_mask:0xf bank_mask:0xf
    v_dot2c_f32_bf16_dpp v55, v253, v79 row_newbcast:6 row_mask:0xf bank_mask:0xf
    s_waitcnt lgkmcnt(3)
    v_dot2c_f32_bf16_dpp v48, v245, v80 row_newbcast:8 row_mask:0xf bank_mask:0xf
    v_dot2c_f32_bf16_dpp v49, v253, v80 row_newbcast:8 row_mask:0xf bank_mask:0xf
    v_dot2c_f32_bf16_dpp v50, v245, v81 row_newbcast:8 row_mask:0xf bank_mask:0xf
    v_dot2c_f32_bf16_dpp v51, v253, v81 row_newbcast:8 row_mask:0xf bank_mask:0xf
    v_dot2c_f32_bf16_dpp v52, v245, v82 row_newbcast:8 row_mask:0xf bank_mask:0xf
    v_dot2c_f32_bf16_dpp v53, v253, v82 row_newbcast:8 row_mask:0xf bank_mask:0xf
    v_dot2c_f32_bf16_dpp v54, v245, v83 row_newbcast:8 row_mask:0xf bank_mask:0xf
    v_dot2c_f32_bf16_dpp v55, v253, v83 row_newbcast:8 row_mask:0xf bank_mask:0xf
    s_waitcnt lgkmcnt(2)
    v_dot2c_f32_bf16_dpp v48, v245, v84 row_newbcast:10 row_mask:0xf bank_mask:0xf
    v_dot2c_f32_bf16_dpp v49, v253, v84 row_newbcast:10 row_mask:0xf bank_mask:0xf
    v_dot2c_f32_bf16_dpp v50, v245, v85 row_newbcast:10 row_mask:0xf bank_mask:0xf
    v_dot2c_f32_bf16_dpp v51, v253, v85 row_newbcast:10 row_mask:0xf bank_mask:0xf
    v_dot2c_f32_bf16_dpp v52, v245, v86 row_newbcast:10 row_mask:0xf bank_mask:0xf
    v_dot2c_f32_bf16_dpp v53, v253, v86 row_newbcast:10 row_mask:0xf bank_mask:0xf
    v_dot2c_f32_bf16_dpp v54, v245, v87 row_newbcast:10 row_mask:0xf bank_mask:0xf
    v_dot2c_f32_bf16_dpp v55, v253, v87 row_newbcast:10 row_mask:0xf bank_mask:0xf
    s_waitcnt lgkmcnt(1)
    v_dot2c_f32_bf16_dpp v48, v245, v88 row_newbcast:12 row_mask:0xf bank_mask:0xf
    v_dot2c_f32_bf16_dpp v49, v253, v88 row_newbcast:12 row_mask:0xf bank_mask:0xf
    v_dot2c_f32_bf16_dpp v50, v245, v89 row_newbcast:12 row_mask:0xf bank_mask:0xf
    v_dot2c_f32_bf16_dpp v51, v253, v89 row_newbcast:12 row_mask:0xf bank_mask:0xf
    v_dot2c_f32_bf16_dpp v52, v245, v90 row_newbcast:12 row_mask:0xf bank_mask:0xf
    v_dot2c_f32_bf16_dpp v53, v253, v90 row_newbcast:12 row_mask:0xf bank_mask:0xf
    v_dot2c_f32_bf16_dpp v54, v245, v91 row_newbcast:12 row_mask:0xf bank_mask:0xf
    v_dot2c_f32_bf16_dpp v55, v253, v91 row_newbcast:12 row_mask:0xf bank_mask:0xf
    s_waitcnt lgkmcnt(0)

    s_mov_b64 exec, 1
    ds_write_b32 v35, v34
    s_mov_b64 exec, -1
    s_add_u32 s72, s72, 5
    s_add_u32 s74, s74, 40960
    s_cmp_ge_u32 s74, 163840
    s_cselect_b32 s30, 147456, 0
    s_sub_u32 s74, s74, s30

    v_dot2c_f32_bf16_dpp v48, v245, v92 row_newbcast:14 row_mask:0xf bank_mask:0xf
    v_dot2c_f32_bf16_dpp v49, v253, v92 row_newbcast:14 row_mask:0xf bank_mask:0xf
    v_dot2c_f32_bf16_dpp v50, v245, v93 row_newbcast:14 row_mask:0xf bank_mask:0xf
    v_dot2c_f32_bf16_dpp v51, v253, v93 row_newbcast:14 row_mask:0xf bank_mask:0xf
    v_dot2c_f32_bf16_dpp v52, v245, v94 row_newbcast:14 row_mask:0xf bank_mask:0xf
    v_dot2c_f32_bf16_dpp v53, v253, v94 row_newbcast:14 row_mask:0xf bank_mask:0xf
    v_dot2c_f32_bf16_dpp v54, v245, v95 row_newbcast:14 row_mask:0xf bank_mask:0xf
    v_dot2c_f32_bf16_dpp v55, v253, v95 row_newbcast:14 row_mask:0xf bank_mask:0xf

    s_cmp_ge_u32 s97, 2
    s_cbranch_scc1 L_v6

    v_mov_b32 v33, 8704
    s_mov_b32 s76, s72

    v_add_u32 v32, s74, v2
    s_mov_b32 s86, 0
        L_lw14:
    ds_read_b32 v10, v33
    s_waitcnt lgkmcnt(0)
    v_readfirstlane_b32 s30, v10
    s_nop 0
    s_cmp_gt_i32 s30, s76
    s_cbranch_scc1 L_lo14
    s_add_u32 s86, s86, 1
    s_cmp_lt_u32 s86, 400000
    s_cbranch_scc1 L_lw14
        L_lo14:

    ds_read_b128 v[64:67], v32 offset:0
    ds_read_b128 v[68:71], v32 offset:1024
    ds_read_b128 v[72:75], v32 offset:2048
    ds_read_b128 v[76:79], v32 offset:3072
    ds_read_b128 v[80:83], v32 offset:4096
    ds_read_b128 v[84:87], v32 offset:5120
    ds_read_b128 v[88:91], v32 offset:6144
    ds_read_b128 v[92:95], v32 offset:7168

    s_sub_u32 s30, s74, 16384
    s_lshr_b32 s30, s30, 11
    s_add_u32 s30, s30, 9216
    v_mov_b32 v35, s30
    s_add_u32 s30, s72, 1
    v_mov_b32 v34, s30

    s_waitcnt lgkmcnt(7)
    v_dot2c_f32_bf16_dpp v48, v246, v64 row_newbcast:0 row_mask:0xf bank_mask:0xf
    v_dot2c_f32_bf16_dpp v49, v254, v64 row_newbcast:0 row_mask:0xf bank_mask:0xf
    v_dot2c_f32_bf16_dpp v50, v246, v65 row_newbcast:0 row_mask:0xf bank_mask:0xf
    v_dot2c_f32_bf16_dpp v51, v254, v65 row_newbcast:0 row_mask:0xf bank_mask:0xf
    v_dot2c_f32_bf16_dpp v52, v246, v66 row_newbcast:0 row_mask:0xf bank_mask:0xf
    v_dot2c_f32_bf16_dpp v53, v254, v66 row_newbcast:0 row_mask:0xf bank_mask:0xf
    v_dot2c_f32_bf16_dpp v54, v246, v67 row_newbcast:0 row_mask:0xf bank_mask:0xf
    v_dot2c_f32_bf16_dpp v55, v254, v67 row_newbcast:0 row_mask:0xf bank_mask:0xf
    s_waitcnt lgkmcnt(6)
    v_dot2c_f32_bf16_dpp v48, v246, v68 row_newbcast:2 row_mask:0xf bank_mask:0xf
    v_dot2c_f32_bf16_dpp v49, v254, v68 row_newbcast:2 row_mask:0xf bank_mask:0xf
    v_dot2c_f32_bf16_dpp v50, v246, v69 row_newbcast:2 row_mask:0xf bank_mask:0xf
    v_dot2c_f32_bf16_dpp v51, v254, v69 row_newbcast:2 row_mask:0xf bank_mask:0xf
    v_dot2c_f32_bf16_dpp v52, v246, v70 row_newbcast:2 row_mask:0xf bank_mask:0xf
    v_dot2c_f32_bf16_dpp v53, v254, v70 row_newbcast:2 row_mask:0xf bank_mask:0xf
    v_dot2c_f32_bf16_dpp v54, v246, v71 row_newbcast:2 row_mask:0xf bank_mask:0xf
    v_dot2c_f32_bf16_dpp v55, v254, v71 row_newbcast:2 row_mask:0xf bank_mask:0xf
    s_waitcnt lgkmcnt(5)
    v_dot2c_f32_bf16_dpp v48, v246, v72 row_newbcast:4 row_mask:0xf bank_mask:0xf
    v_dot2c_f32_bf16_dpp v49, v254, v72 row_newbcast:4 row_mask:0xf bank_mask:0xf
    v_dot2c_f32_bf16_dpp v50, v246, v73 row_newbcast:4 row_mask:0xf bank_mask:0xf
    v_dot2c_f32_bf16_dpp v51, v254, v73 row_newbcast:4 row_mask:0xf bank_mask:0xf
    v_dot2c_f32_bf16_dpp v52, v246, v74 row_newbcast:4 row_mask:0xf bank_mask:0xf
    v_dot2c_f32_bf16_dpp v53, v254, v74 row_newbcast:4 row_mask:0xf bank_mask:0xf
    v_dot2c_f32_bf16_dpp v54, v246, v75 row_newbcast:4 row_mask:0xf bank_mask:0xf
    v_dot2c_f32_bf16_dpp v55, v254, v75 row_newbcast:4 row_mask:0xf bank_mask:0xf
    s_waitcnt lgkmcnt(4)
    v_dot2c_f32_bf16_dpp v48, v246, v76 row_newbcast:6 row_mask:0xf bank_mask:0xf
    v_dot2c_f32_bf16_dpp v49, v254, v76 row_newbcast:6 row_mask:0xf bank_mask:0xf
    v_dot2c_f32_bf16_dpp v50, v246, v77 row_newbcast:6 row_mask:0xf bank_mask:0xf
    v_dot2c_f32_bf16_dpp v51, v254, v77 row_newbcast:6 row_mask:0xf bank_mask:0xf
    v_dot2c_f32_bf16_dpp v52, v246, v78 row_newbcast:6 row_mask:0xf bank_mask:0xf
    v_dot2c_f32_bf16_dpp v53, v254, v78 row_newbcast:6 row_mask:0xf bank_mask:0xf
    v_dot2c_f32_bf16_dpp v54, v246, v79 row_newbcast:6 row_mask:0xf bank_mask:0xf
    v_dot2c_f32_bf16_dpp v55, v254, v79 row_newbcast:6 row_mask:0xf bank_mask:0xf
    s_waitcnt lgkmcnt(3)
    v_dot2c_f32_bf16_dpp v48, v246, v80 row_newbcast:8 row_mask:0xf bank_mask:0xf
    v_dot2c_f32_bf16_dpp v49, v254, v80 row_newbcast:8 row_mask:0xf bank_mask:0xf
    v_dot2c_f32_bf16_dpp v50, v246, v81 row_newbcast:8 row_mask:0xf bank_mask:0xf
    v_dot2c_f32_bf16_dpp v51, v254, v81 row_newbcast:8 row_mask:0xf bank_mask:0xf
    v_dot2c_f32_bf16_dpp v52, v246, v82 row_newbcast:8 row_mask:0xf bank_mask:0xf
    v_dot2c_f32_bf16_dpp v53, v254, v82 row_newbcast:8 row_mask:0xf bank_mask:0xf
    v_dot2c_f32_bf16_dpp v54, v246, v83 row_newbcast:8 row_mask:0xf bank_mask:0xf
    v_dot2c_f32_bf16_dpp v55, v254, v83 row_newbcast:8 row_mask:0xf bank_mask:0xf
    s_waitcnt lgkmcnt(2)
    v_dot2c_f32_bf16_dpp v48, v246, v84 row_newbcast:10 row_mask:0xf bank_mask:0xf
    v_dot2c_f32_bf16_dpp v49, v254, v84 row_newbcast:10 row_mask:0xf bank_mask:0xf
    v_dot2c_f32_bf16_dpp v50, v246, v85 row_newbcast:10 row_mask:0xf bank_mask:0xf
    v_dot2c_f32_bf16_dpp v51, v254, v85 row_newbcast:10 row_mask:0xf bank_mask:0xf
    v_dot2c_f32_bf16_dpp v52, v246, v86 row_newbcast:10 row_mask:0xf bank_mask:0xf
    v_dot2c_f32_bf16_dpp v53, v254, v86 row_newbcast:10 row_mask:0xf bank_mask:0xf
    v_dot2c_f32_bf16_dpp v54, v246, v87 row_newbcast:10 row_mask:0xf bank_mask:0xf
    v_dot2c_f32_bf16_dpp v55, v254, v87 row_newbcast:10 row_mask:0xf bank_mask:0xf
    s_waitcnt lgkmcnt(1)
    v_dot2c_f32_bf16_dpp v48, v246, v88 row_newbcast:12 row_mask:0xf bank_mask:0xf
    v_dot2c_f32_bf16_dpp v49, v254, v88 row_newbcast:12 row_mask:0xf bank_mask:0xf
    v_dot2c_f32_bf16_dpp v50, v246, v89 row_newbcast:12 row_mask:0xf bank_mask:0xf
    v_dot2c_f32_bf16_dpp v51, v254, v89 row_newbcast:12 row_mask:0xf bank_mask:0xf
    v_dot2c_f32_bf16_dpp v52, v246, v90 row_newbcast:12 row_mask:0xf bank_mask:0xf
    v_dot2c_f32_bf16_dpp v53, v254, v90 row_newbcast:12 row_mask:0xf bank_mask:0xf
    v_dot2c_f32_bf16_dpp v54, v246, v91 row_newbcast:12 row_mask:0xf bank_mask:0xf
    v_dot2c_f32_bf16_dpp v55, v254, v91 row_newbcast:12 row_mask:0xf bank_mask:0xf
    s_waitcnt lgkmcnt(0)

    s_mov_b64 exec, 1
    ds_write_b32 v35, v34
    s_mov_b64 exec, -1
    s_add_u32 s72, s72, 5
    s_add_u32 s74, s74, 40960
    s_cmp_ge_u32 s74, 163840
    s_cselect_b32 s30, 147456, 0
    s_sub_u32 s74, s74, s30

    v_dot2c_f32_bf16_dpp v48, v246, v92 row_newbcast:14 row_mask:0xf bank_mask:0xf
    v_dot2c_f32_bf16_dpp v49, v254, v92 row_newbcast:14 row_mask:0xf bank_mask:0xf
    v_dot2c_f32_bf16_dpp v50, v246, v93 row_newbcast:14 row_mask:0xf bank_mask:0xf
    v_dot2c_f32_bf16_dpp v51, v254, v93 row_newbcast:14 row_mask:0xf bank_mask:0xf
    v_dot2c_f32_bf16_dpp v52, v246, v94 row_newbcast:14 row_mask:0xf bank_mask:0xf
    v_dot2c_f32_bf16_dpp v53, v254, v94 row_newbcast:14 row_mask:0xf bank_mask:0xf
    v_dot2c_f32_bf16_dpp v54, v246, v95 row_newbcast:14 row_mask:0xf bank_mask:0xf
    v_dot2c_f32_bf16_dpp v55, v254, v95 row_newbcast:14 row_mask:0xf bank_mask:0xf
L_v6:
L_tail:
    s_nop 2
    v_permlane32_swap_b32 v48, v52
    v_permlane32_swap_b32 v49, v53
    v_permlane32_swap_b32 v50, v54
    v_permlane32_swap_b32 v51, v55
    v_add_f32 v48, v48, v52
    v_add_f32 v49, v49, v53
    v_add_f32 v50, v50, v54
    v_add_f32 v51, v51, v55
    s_nop 0
    v_permlane16_swap_b32 v48, v50
    v_permlane16_swap_b32 v49, v51
    v_add_f32 v48, v48, v50
    v_add_f32 v49, v49, v51

    s_lshl_b32 s30, s3, 9
    v_lshlrev_b32 v10, 5, v3
    v_lshl_add_u32 v10, v4, 3, v10
    v_add_u32 v10, s30, v10
    v_mul_f32 v48, v48, v62
    v_mul_f32 v49, v49, v62
    ds_write_b64 v10, v[48:49] offset:4096
    L_barC:

    s_waitcnt lgkmcnt(0)
    s_barrier
    s_cmp_lt_u32 s97, 5
    s_cbranch_scc1 L_nopub2
    s_cmp_lg_u32 s3, 0
    s_cbranch_scc1 L_wait4
    s_mov_b32 exec_hi, 0

    ds_read_b128 v[16:19], v2 offset:4608
    ds_read_b128 v[20:23], v2 offset:5120
    ds_read_b128 v[24:27], v2 offset:5632
    ds_read_b128 v[28:31], v2 offset:6144
    ds_read_b128 v[48:51], v2 offset:6656
    s_waitcnt lgkmcnt(3)
    v_add_f32 v16, v16, v20
    v_add_f32 v17, v17, v21
    v_add_f32 v18, v18, v22
    v_add_f32 v19, v19, v23
    s_waitcnt lgkmcnt(1)
    v_add_f32 v24, v24, v28
    v_add_f32 v25, v25, v29
    v_add_f32 v26, v26, v30
    v_add_f32 v27, v27, v31
    s_waitcnt lgkmcnt(0)
    v_add_f32 v16, v16, v48
    v_add_f32 v17, v17, v49
    v_add_f32 v18, v18, v50
    v_add_f32 v19, v19, v51
    v_add_f32 v116, v16, v24
    v_add_f32 v117, v17, v25
    v_add_f32 v118, v18, v26
    v_add_f32 v119, v19, v27
    v_and_or_b32 v116, v116, v6, s57
    v_and_or_b32 v117, v117, v6, s58
    v_and_or_b32 v118, v118, v6, s59
    v_and_or_b32 v119, v119, v6, s60
    global_store_dwordx4 v120, v[116:119], s[82:83]
    s_mov_b64 exec, -1

    L_wait4:
    s_nop 0
    s_cmp_lg_u32 s3, 0
    s_cselect_b32 s31, 1, 0
    s_cmp_eq_u32 s77, 0
    s_cselect_b32 s31, s31, 0
    s_cmp_eq_u32 s31, 1
    s_cbranch_scc1 L_fin
    v_mov_b32 v12, 8480
    s_mov_b32 s86, 0
    L_w4:

    ds_read_b32 v13, v12
    s_waitcnt lgkmcnt(0)
    v_readfirstlane_b32 s30, v13
    s_nop 0
    s_cmp_lt_u32 s30, 256
    s_cbranch_scc1 L_w4n
    s_cmp_lg_u32 s3, 0
    s_cbranch_scc1 L_w4n
    s_cmp_eq_u32 s75, 7
    s_cbranch_scc1 L_w4n

    s_mov_b64 exec, 1
    global_store_dwordx4 v104, v[100:103], s[84:85] sc1
    s_mov_b32 exec_lo, -1
    global_store_dwordx4 v112, v[108:111], s[24:25] sc1
    global_store_dwordx4 v120, v[116:119], s[92:93] sc1
    s_mov_b32 exec_hi, -1
    s_mov_b32 s75, 7

    L_w4n:
    s_nop 0
    s_and_b32 s30, s30, 255
    s_cmp_ge_u32 s30, 5
    s_cbranch_scc1 L_w4d
    s_add_u32 s86, s86, 1
    s_cmp_lt_u32 s86, 4000000
    s_cbranch_scc1 L_w4
    L_w4d:
    s_nop 0
    s_cmp_lg_u32 s3, 0
    s_cbranch_scc1 L_red
    s_cmp_eq_u32 s75, 7
    s_cbranch_scc1 L_red

    s_mov_b64 exec, 1
    global_store_dwordx4 v104, v[100:103], s[84:85] sc1
    s_mov_b32 exec_lo, -1
    global_store_dwordx4 v112, v[108:111], s[24:25] sc1
    global_store_dwordx4 v120, v[116:119], s[92:93] sc1
    s_mov_b32 exec_hi, -1
    s_mov_b32 s75, 7

    s_branch L_red
    L_nopub2:

    s_mov_b64 s[0:1], s[82:83]

    s_mov_b32 s86, 0
    L_p3x_ld:
    global_load_dwordx4 v[64:67], v97, s[0:1] sc1
    s_waitcnt vmcnt(0)

    v_perm_b32 v10, v65, v64, s61
    v_perm_b32 v11, v67, v66, s62
    v_or_b32 v10, v10, v11

    v_cmp_ne_u32 vcc, s56, v10
    s_cbranch_vccz L_p3x_ok
    s_mov_b64 exec, vcc
    s_add_u32 s86, s86, 1

    s_cmp_lg_u32 s86, 62
    s_cbranch_scc1 L_p3x_nf
    s_mov_b64 s[68:69], exec
    s_mov_b64 exec, 1
    v_mov_b32 v12, 8480
    v_mov_b32 v13, 256
    ds_add_u32 v12, v13

    s_mov_b64 exec, -1
    s_cmp_eq_u32 s79, 0
    s_cbranch_scc1 L_p3x_nff

    v_mov_b32 v12, 8456
    ds_read_b32 v13, v12
    ds_read_b128 v[16:19], v180 offset:2048
    ds_read_b128 v[20:23], v180 offset:2560
    s_waitcnt lgkmcnt(0)
    v_readfirstlane_b32 s30, v13
    s_nop 0
    s_cmp_lt_u32 s30, 3
    s_cbranch_scc1 L_ffl2
    s_mov_b32 exec_hi, 0

    v_add_f32 v16, v16, v20
    v_add_f32 v17, v17, v21
    v_add_f32 v18, v18, v22
    v_add_f32 v19, v19, v23
    s_mov_b32 exec_hi, -1
    v_and_or_b32 v16, v16, v6, s57
    v_and_or_b32 v17, v17, v6, s58
    v_and_or_b32 v18, v18, v6, s59
    v_and_or_b32 v19, v19, v6, s60

    s_add_u32 s0, s94, 1048576
    s_addc_u32 s1, s95, 0
    global_store_dwordx4 v112, v[16:19], s[0:1] sc1
        L_ffl2:

L_p3x_nff:

    s_mov_b64 exec, s[68:69]
    L_p3x_nf:

    s_and_b32 s31, s86, 63
    s_cmp_eq_u32 s31, 63
    s_cselect_b32 s0, s92, s82
    s_cselect_b32 s1, s93, s83

    s_cmp_lt_u32 s86, s87
    s_cbranch_scc1 L_p3x_ld
    L_p3x_ok:
    s_mov_b64 exec, -1

    v_and_b32 v64, v64, v6
    v_and_b32 v65, v65, v6
    v_and_b32 v66, v66, v6
    v_and_b32 v67, v67, v6
    v_add_f32_dpp v64, v64, v64 quad_perm:[1,0,3,2] row_mask:0xf bank_mask:0xf
    v_add_f32_dpp v65, v65, v65 quad_perm:[1,0,3,2] row_mask:0xf bank_mask:0xf
    v_add_f32_dpp v66, v66, v66 quad_perm:[1,0,3,2] row_mask:0xf bank_mask:0xf
    v_add_f32_dpp v67, v67, v67 quad_perm:[1,0,3,2] row_mask:0xf bank_mask:0xf
    v_add_f32_dpp v64, v64, v64 quad_perm:[2,3,0,1] row_mask:0xf bank_mask:0xf
    v_add_f32_dpp v65, v65, v65 quad_perm:[2,3,0,1] row_mask:0xf bank_mask:0xf
    v_add_f32_dpp v66, v66, v66 quad_perm:[2,3,0,1] row_mask:0xf bank_mask:0xf
    v_add_f32_dpp v67, v67, v67 quad_perm:[2,3,0,1] row_mask:0xf bank_mask:0xf
    v_add_f32_dpp v64, v64, v64 row_half_mirror row_mask:0xf bank_mask:0xf
    v_add_f32_dpp v65, v65, v65 row_half_mirror row_mask:0xf bank_mask:0xf
    v_add_f32_dpp v66, v66, v66 row_half_mirror row_mask:0xf bank_mask:0xf
    v_add_f32_dpp v67, v67, v67 row_half_mirror row_mask:0xf bank_mask:0xf
    v_cvt_pk_bf16_f32 v20, 0, v64
    v_cvt_pk_bf16_f32 v21, 0, v65
    v_cvt_pk_bf16_f32 v22, 0, v66
    v_cvt_pk_bf16_f32 v23, 0, v67
    v_lshrrev_b32 v16, 16, v20
    v_lshrrev_b32 v17, 16, v21
    v_lshrrev_b32 v18, 16, v22
    v_lshrrev_b32 v19, 16, v23
    v_dot2c_f32_bf16_dpp v36, v16, v148 row_newbcast:0 row_mask:0xf bank_mask:0xf
    v_dot2c_f32_bf16_dpp v37, v20, v148 row_newbcast:0 row_mask:0xf bank_mask:0xf
    v_dot2c_f32_bf16_dpp v38, v16, v149 row_newbcast:0 row_mask:0xf bank_mask:0xf
    v_dot2c_f32_bf16_dpp v39, v20, v149 row_newbcast:0 row_mask:0xf bank_mask:0xf
    v_dot2c_f32_bf16_dpp v40, v16, v150 row_newbcast:0 row_mask:0xf bank_mask:0xf
    v_dot2c_f32_bf16_dpp v41, v20, v150 row_newbcast:0 row_mask:0xf bank_mask:0xf
    v_dot2c_f32_bf16_dpp v42, v16, v151 row_newbcast:0 row_mask:0xf bank_mask:0xf
    v_dot2c_f32_bf16_dpp v43, v20, v151 row_newbcast:0 row_mask:0xf bank_mask:0xf
    v_dot2c_f32_bf16_dpp v36, v17, v152 row_newbcast:0 row_mask:0xf bank_mask:0xf
    v_dot2c_f32_bf16_dpp v37, v21, v152 row_newbcast:0 row_mask:0xf bank_mask:0xf
    v_dot2c_f32_bf16_dpp v38, v17, v153 row_newbcast:0 row_mask:0xf bank_mask:0xf
    v_dot2c_f32_bf16_dpp v39, v21, v153 row_newbcast:0 row_mask:0xf bank_mask:0xf
    v_dot2c_f32_bf16_dpp v40, v17, v154 row_newbcast:0 row_mask:0xf bank_mask:0xf
    v_dot2c_f32_bf16_dpp v41, v21, v154 row_newbcast:0 row_mask:0xf bank_mask:0xf
    v_dot2c_f32_bf16_dpp v42, v17, v155 row_newbcast:0 row_mask:0xf bank_mask:0xf
    v_dot2c_f32_bf16_dpp v43, v21, v155 row_newbcast:0 row_mask:0xf bank_mask:0xf
    v_dot2c_f32_bf16_dpp v36, v18, v156 row_newbcast:0 row_mask:0xf bank_mask:0xf
    v_dot2c_f32_bf16_dpp v37, v22, v156 row_newbcast:0 row_mask:0xf bank_mask:0xf
    v_dot2c_f32_bf16_dpp v38, v18, v157 row_newbcast:0 row_mask:0xf bank_mask:0xf
    v_dot2c_f32_bf16_dpp v39, v22, v157 row_newbcast:0 row_mask:0xf bank_mask:0xf
    v_dot2c_f32_bf16_dpp v40, v18, v158 row_newbcast:0 row_mask:0xf bank_mask:0xf
    v_dot2c_f32_bf16_dpp v41, v22, v158 row_newbcast:0 row_mask:0xf bank_mask:0xf
    v_dot2c_f32_bf16_dpp v42, v18, v159 row_newbcast:0 row_mask:0xf bank_mask:0xf
    v_dot2c_f32_bf16_dpp v43, v22, v159 row_newbcast:0 row_mask:0xf bank_mask:0xf
    v_dot2c_f32_bf16_dpp v36, v19, v160 row_newbcast:0 row_mask:0xf bank_mask:0xf
    v_dot2c_f32_bf16_dpp v37, v23, v160 row_newbcast:0 row_mask:0xf bank_mask:0xf
    v_dot2c_f32_bf16_dpp v38, v19, v161 row_newbcast:0 row_mask:0xf bank_mask:0xf
    v_dot2c_f32_bf16_dpp v39, v23, v161 row_newbcast:0 row_mask:0xf bank_mask:0xf
    v_dot2c_f32_bf16_dpp v40, v19, v162 row_newbcast:0 row_mask:0xf bank_mask:0xf
    v_dot2c_f32_bf16_dpp v41, v23, v162 row_newbcast:0 row_mask:0xf bank_mask:0xf
    v_dot2c_f32_bf16_dpp v42, v19, v163 row_newbcast:0 row_mask:0xf bank_mask:0xf
    v_dot2c_f32_bf16_dpp v43, v23, v163 row_newbcast:0 row_mask:0xf bank_mask:0xf
    v_permlane32_swap_b32 v36, v40
    v_permlane32_swap_b32 v37, v41
    v_permlane32_swap_b32 v38, v42
    v_permlane32_swap_b32 v39, v43
    v_add_f32 v36, v36, v40
    v_add_f32 v37, v37, v41
    v_add_f32 v38, v38, v42
    v_add_f32 v39, v39, v43
    s_nop 0
    v_permlane16_swap_b32 v36, v38
    v_permlane16_swap_b32 v37, v39
    v_add_f32 v36, v36, v38
    v_add_f32 v37, v37, v39
    s_nop 0
    v_permlane16_swap_b32 v36, v38
    v_permlane16_swap_b32 v37, v39
    v_and_or_b32 v36, v36, v6, s57
    v_and_or_b32 v37, v37, v6, s58
    v_and_or_b32 v38, v38, v6, s59
    v_and_or_b32 v39, v39, v6, s60

    s_and_b32 exec_lo, exec_lo, 0xffff
    s_and_b32 exec_hi, exec_hi, 0xffff
    global_store_dwordx4 v60, v[36:39], s[84:85] sc1
    s_mov_b64 exec, 1
    v_mov_b32 v12, 8480
    v_mov_b32 v13, 1
    ds_add_u32 v12, v13
    s_mov_b64 exec, -1

        L_red:
    s_cmp_eq_u32 s77, 0
    s_cbranch_scc1 L_fin
    v_and_b32 v14, 7, v1
    v_lshlrev_b32 v14, 4, v14
    s_lshl_b32 s30, s3, 7
    v_add_u32 v14, s30, v14
    s_mov_b32 s86, 0
        L_p3_ld:

    global_load_dwordx4 v[64:67], v2, s[98:99] offset:0 sc1
    global_load_dwordx4 v[68:71], v2, s[98:99] offset:1024 sc1
    global_load_dwordx4 v[72:75], v2, s[98:99] offset:2048 sc1
    global_load_dwordx4 v[76:79], v2, s[98:99] offset:3072 sc1
    s_waitcnt vmcnt(0)
    v_perm_b32 v10, v65, v64, s61
    v_perm_b32 v11, v67, v66, s62
    v_or_b32 v10, v10, v11
    v_perm_b32 v12, v69, v68, s61
    v_perm_b32 v13, v71, v70, s62
    v_or_b32 v12, v12, v13
    v_perm_b32 v16, v73, v72, s61
    v_perm_b32 v17, v75, v74, s62
    v_or_b32 v16, v16, v17
    v_perm_b32 v18, v77, v76, s61
    v_perm_b32 v19, v79, v78, s62
    v_or_b32 v18, v18, v19
    v_xor_b32 v10, s56, v10
    v_xor_b32 v12, s56, v12
    v_xor_b32 v16, s56, v16
    v_xor_b32 v18, s56, v18

    v_or3_b32 v10, v10, v12, v16
    v_or_b32 v10, v10, v18
    v_cmp_ne_u32 vcc, 0, v10
    s_cbranch_vccz L_p3_ok
    s_mov_b64 exec, vcc
    s_add_u32 s86, s86, 1
    s_cmp_lg_u32 s86, 62
    s_cbranch_scc1 L_p3_nf
    s_cmp_lg_u32 s3, 0
    s_cbranch_scc1 L_p3_nf
    s_mov_b64 s[68:69], exec

    s_mov_b64 exec, 1
    global_store_dwordx4 v104, v[100:103], s[84:85] sc1
    s_mov_b32 exec_lo, -1
    global_store_dwordx4 v112, v[108:111], s[24:25] sc1
    global_store_dwordx4 v120, v[116:119], s[92:93] sc1
    s_mov_b32 exec_hi, -1
    s_mov_b32 s75, 7

    s_mov_b64 exec, s[68:69]
        L_p3_nf:
    s_cmp_lt_u32 s86, s87
    s_cbranch_scc1 L_p3_ld
        L_p3_ok:
    s_mov_b64 exec, -1

    v_and_b32 v64, v64, v6
    v_and_b32 v65, v65, v6
    v_and_b32 v66, v66, v6
    v_and_b32 v67, v67, v6
    v_and_b32 v68, v68, v6
    v_and_b32 v69, v69, v6
    v_and_b32 v70, v70, v6
    v_and_b32 v71, v71, v6
    v_and_b32 v72, v72, v6
    v_and_b32 v73, v73, v6
    v_and_b32 v74, v74, v6
    v_and_b32 v75, v75, v6
    v_and_b32 v76, v76, v6
    v_and_b32 v77, v77, v6
    v_and_b32 v78, v78, v6
    v_and_b32 v79, v79, v6
    v_add_f32 v64, v64, v68
    v_add_f32 v65, v65, v69
    v_add_f32 v66, v66, v70
    v_add_f32 v67, v67, v71
    v_add_f32 v72, v72, v76
    v_add_f32 v73, v73, v77
    v_add_f32 v74, v74, v78
    v_add_f32 v75, v75, v79
    v_add_f32 v64, v64, v72
    v_add_f32 v65, v65, v73
    v_add_f32 v66, v66, v74
    v_add_f32 v67, v67, v75
    v_add_f32_dpp v64, v64, v64 row_ror:8 row_mask:0xf bank_mask:0xf
    v_add_f32_dpp v65, v65, v65 row_ror:8 row_mask:0xf bank_mask:0xf
    v_add_f32_dpp v66, v66, v66 row_ror:8 row_mask:0xf bank_mask:0xf
    v_add_f32_dpp v67, v67, v67 row_ror:8 row_mask:0xf bank_mask:0xf
    v_mov_b32 v68, v64
    v_mov_b32 v69, v65
    v_mov_b32 v70, v66
    v_mov_b32 v71, v67
    v_permlane16_swap_b32 v68, v64
    v_permlane16_swap_b32 v69, v65
    v_permlane16_swap_b32 v70, v66
    v_permlane16_swap_b32 v71, v67
    v_add_f32 v64, v64, v68
    v_add_f32 v65, v65, v69
    v_add_f32 v66, v66, v70
    v_add_f32 v67, v67, v71
    v_mov_b32 v68, v64
    v_mov_b32 v69, v65
    v_mov_b32 v70, v66
    v_mov_b32 v71, v67
    v_permlane32_swap_b32 v68, v64
    v_permlane32_swap_b32 v69, v65
    v_permlane32_swap_b32 v70, v66
    v_permlane32_swap_b32 v71, v67
    v_add_f32 v64, v64, v68
    v_add_f32 v65, v65, v69
    v_add_f32 v66, v66, v70
    v_add_f32 v67, v67, v71

    s_mov_b64 exec, 0xff
    ds_write_b128 v14, v[64:67] offset:9472
    s_mov_b64 exec, -1
    v_and_b32 v13, 31, v1
    v_lshlrev_b32 v10, 2, v13
    v_lshrrev_b32 v11, 5, v1
    v_lshl_add_u32 v10, v11, 9, v10
    v_lshlrev_b32 v13, 1, v13
    s_waitcnt lgkmcnt(0)
    s_barrier
    s_cmp_lg_u32 s3, 0
    s_cbranch_scc1 L_fin

    ds_read_b32 v16, v10 offset:9472
    ds_read_b32 v17, v10 offset:9600
    ds_read_b32 v18, v10 offset:9728
    ds_read_b32 v19, v10 offset:9856

    v_lshlrev_b32 v61, 16, v61
    s_lshl_b32 s30, s96, 6
    s_mov_b32 s52, s22
    s_mov_b32 s53, s23
    s_waitcnt lgkmcnt(0)
    v_add_f32 v16, v16, v17
    v_add_f32 v18, v18, v19
    v_add_f32 v11, v16, v18

    v_mov_b32 v12, v11
    s_nop 1
    v_permlane32_swap_b32 v12, v11
    v_add_f32 v11, v11, v12

    v_add_f32 v11, v11, v61
    v_cvt_pk_bf16_f32 v11, v11, v11
    s_mov_b32 exec_hi, 0
    buffer_store_short v11, v13, s[52:55], s30 offen

    s_mov_b64 exec, -1
    s_cmp_lg_u32 s96, 0
    s_cbranch_scc1 L_fin
    v_mov_b32 v10, 0
    v_mov_b32 v11, s56
    s_and_b64 exec, exec, 1
    global_store_dword v10, v11, s[26:27]
    s_mov_b64 exec, -1
    L_fin:
    s_nop 0
    s_cmp_lg_u32 s3, 0
    s_cbranch_scc1 L_fin2
    s_cmp_eq_u32 s75, 7
    s_cbranch_scc1 L_fin2

    s_mov_b64 exec, 1
    global_store_dwordx4 v104, v[100:103], s[84:85] sc1
    s_mov_b32 exec_lo, -1
    global_store_dwordx4 v112, v[108:111], s[24:25] sc1
    global_store_dwordx4 v120, v[116:119], s[92:93] sc1
    s_mov_b32 exec_hi, -1
    s_mov_b32 s75, 7

    L_fin2:

    L_end:
    s_endpgm

.section .rodata,"a"
.p2align 6
.amdhsa_kernel parallel_sum__gqa_block_cached__glu_gated_swiglu__decode_kernel
  .amdhsa_next_free_vgpr 256
  .amdhsa_next_free_sgpr 102
  .amdhsa_accum_offset 256
  .amdhsa_group_segment_fixed_size 0
  .amdhsa_kernarg_size 96
  .amdhsa_user_sgpr_count 2
  .amdhsa_user_sgpr_kernarg_segment_ptr 1
  .amdhsa_system_sgpr_workgroup_id_x 1
  .amdhsa_float_denorm_mode_32 3
.end_amdhsa_kernel
```
